```python
import torch

def _softmax(x, axis=-1):
    return torch.softmax(x, dim=axis)
def _gelu(x):
    return torch.nn.functional.gelu(x, approximate="tanh")
def _silu(x):
    return torch.nn.functional.silu(x)
def _sigmoid(x):
    return torch.sigmoid(x)
def _layernorm(x, axis=-1, eps=1e-5):
    m = x.mean(dim=axis, keepdim=True)
    v = x.var(dim=axis, keepdim=True, unbiased=False)
    return (x - m) / torch.sqrt(v + eps)
def _scatter_add(tgt, idx, src, axis=0):
    return tgt.clone().index_add_(axis, idx, src)
def _segment_sum(src, seg, n):
    out = torch.zeros((n,) + src.shape[1:], dtype=src.dtype)
    return out.index_add_(0, seg, src)
def _pad(x, pw):
    flat = tuple(v for pair in reversed(pw) for v in pair)
    return torch.nn.functional.pad(x, flat)

kernel_name = 'parallel_sum__mha_block_cached__swiglu_ffn__decode'

def setup_inputs():

    _w = (lambda a: (lambda t: t.to(torch.bfloat16) if t.is_floating_point() else t)(torch.as_tensor(a)))
    def _A_setup():
        B, Sq, D = 1, 1, 640
        H, Sk, Dh = 32, 16384, 128
        return {
            "x": _w((lambda *s: torch.randn(*s, dtype=torch.bfloat16) * 0.05)(B, Sq, D)),
            "k_cache": _w((lambda *s: torch.randn(*s, dtype=torch.bfloat16) * 3.2)(B, H, Sk, Dh)),
            "v_cache": _w((lambda *s: torch.randn(*s, dtype=torch.bfloat16) * 1.6)(B, H, Sk, Dh)),
            "wq": _w((lambda *s: torch.randn(*s, dtype=torch.bfloat16) * 3.2)(D, H * Dh) * (D ** -0.5)),
            "wo": _w((lambda *s: torch.randn(*s, dtype=torch.bfloat16) * 1.6)(H * Dh, D) * ((H * Dh) ** -0.5)),
        }
    _A_in = _A_setup()

    def _B_setup():
        B, S, D, F = 1, 1, 640, 1728
        return {
            "x": _w((lambda *s: torch.randn(*s, dtype=torch.bfloat16) * 0.05)(B, S, D)),
            "w_gate": _w((lambda *s: torch.randn(*s, dtype=torch.bfloat16) * 0.05)(D, F)),
            "w_up": _w((lambda *s: torch.randn(*s, dtype=torch.bfloat16) * 0.05)(D, F)),
            "w_down": _w((lambda *s: torch.randn(*s, dtype=torch.bfloat16) * 0.05)(F, D)),
        }
    _B_in = _B_setup()

    return {
        "A_x": _A_in["x"],
        "A_k_cache": _A_in["k_cache"],
        "A_v_cache": _A_in["v_cache"],
        "A_wq": _A_in["wq"],
        "A_wo": _A_in["wo"],
        "B_x": _B_in["x"],
        "B_w_gate": _B_in["w_gate"],
        "B_w_up": _B_in["w_up"],
        "B_w_down": _B_in["w_down"],
    }

def reference(A_x, A_k_cache, A_v_cache, A_wq, A_wo, B_x, B_w_gate, B_w_up, B_w_down):
    def _A_ref(x, k_cache, v_cache, wq, wo):
        B, Sq, D = x.shape
        H, Dh = 32, 128
        q = (lambda x, *d: x.permute(*d))((x @ wq).reshape(B, Sq, H, Dh), 0, 2, 1, 3)
        scores = torch.einsum("bhqd,bhkd->bhqk", q, k_cache) * (Dh ** -0.5)
        p = _softmax(scores, axis=-1)
        o = torch.einsum("bhqk,bhkd->bhqd", p, v_cache)
        return (lambda x, *d: x.permute(*d))(o, 0, 2, 1, 3).reshape(B, Sq, H * Dh) @ wo

    def _B_ref(x, w_gate, w_up, w_down):
        g = _silu(x @ w_gate)
        u = x @ w_up
        return (g * u) @ w_down

    x = A_x
    xn = _layernorm(x, axis=-1)
    return x + _A_ref(xn, A_k_cache, A_v_cache, A_wq, A_wo) + _B_ref(xn, B_w_gate, B_w_up, B_w_down)
```

```asm
; @launch grid=(256,1,1) block=(512,1,1) lds=4608
.amdgcn_target "amdgcn-amd-amdhsa--gfx950"
.text
.globl parallel_sum__mha_block_cached__swiglu_ffn__decode_kernel
.p2align 8
.type parallel_sum__mha_block_cached__swiglu_ffn__decode_kernel,@function
parallel_sum__mha_block_cached__swiglu_ffn__decode_kernel:
    s_load_dwordx16 s[4:19], s[0:1], 0
    s_load_dwordx8 s[20:27], s[0:1], 64
    s_cmp_ge_u32 s2, 256
    s_cbranch_scc1 L_end
    v_lshrrev_b32 v2, 6, v0
    v_and_b32 v1, 63, v0
    v_readfirstlane_b32 s3, v2
    s_cmp_lt_u32 s3, 3
    s_cbranch_scc1 L_helper
    s_and_b32 s35, s3, 3
    s_lshl_b32 s34, s2, 19
    s_lshl_b32 s47, s35, 3
    s_lshl_b32 s35, s35, 10
    s_add_u32 s34, s34, s35
    v_and_b32 v4, 12, v1
    v_lshlrev_b32 v4, 6, v4
    v_and_b32 v5, 3, v1
    v_lshl_add_u32 v4, v5, 4, v4
    v_and_b32 v5, 48, v1
    v_lshl_add_u32 v4, v5, 2, v4
    v_add_u32 v4, s34, v4
    s_lshr_b32 s48, s2, 4
    s_add_u32 s48, s48, s2
    s_and_b32 s48, s48, 15
    s_lshl_b32 s48, s48, 12
    s_add_u32 s49, s48, 4096
    s_and_b32 s49, s49, 65535
    s_add_u32 s50, s49, 4096
    s_and_b32 s50, s50, 65535
    s_add_u32 s51, s50, 4096
    s_and_b32 s51, s51, 65535
    s_add_u32 s52, s51, 4096
    s_and_b32 s52, s52, 65535
    s_add_u32 s53, s52, 4096
    s_and_b32 s53, s53, 65535
    s_add_u32 s54, s53, 4096
    s_and_b32 s54, s54, 65535
    s_add_u32 s55, s54, 4096
    s_and_b32 s55, s55, 65535
    s_add_u32 s56, s55, 4096
    s_and_b32 s56, s56, 65535
    s_add_u32 s57, s56, 4096
    s_and_b32 s57, s57, 65535
    s_add_u32 s58, s57, 4096
    s_and_b32 s58, s58, 65535
    s_add_u32 s59, s58, 4096
    s_and_b32 s59, s59, 65535
    s_add_u32 s60, s59, 4096
    s_and_b32 s60, s60, 65535
    s_add_u32 s61, s60, 4096
    s_and_b32 s61, s61, 65535
    s_add_u32 s62, s61, 4096
    s_and_b32 s62, s62, 65535
    s_add_u32 s63, s62, 4096
    s_and_b32 s63, s63, 65535
    s_mov_b32 s38, 0x8000000
    s_mov_b32 s39, 0x20000
    s_cmp_eq_u32 s3, 3
    s_waitcnt lgkmcnt(0)
    s_mov_b32 s36, s6
    s_mov_b32 s37, s7
    s_cbranch_scc1 L_rest
    buffer_load_dwordx4 v[40:43], v4, s[36:39], s48 offen nt
    buffer_load_dwordx4 v[44:47], v4, s[36:39], s49 offen nt
    buffer_load_dwordx4 v[48:51], v4, s[36:39], s50 offen nt
    buffer_load_dwordx4 v[52:55], v4, s[36:39], s51 offen nt
    buffer_load_dwordx4 v[56:59], v4, s[36:39], s52 offen nt
    buffer_load_dwordx4 v[60:63], v4, s[36:39], s53 offen nt
L_rest:
    s_mov_b32 s40, s6
    s_mov_b32 s41, s7
    s_mov_b32 s42, 0x8000000
    s_mov_b32 s43, 0x20000
    v_add_u32 v3, 0x10000, v4
    v_add_u32 v7, 0x10000, v3
    v_add_u32 v5, 0x10000, v7
    v_lshlrev_b32 v2, 4, v1
    v_add_u32 v2, s34, v2
    v_and_b32 v6, 60, v1
    v_lshlrev_b32 v6, 2, v6
    s_cselect_b32 s44, 6, 2
    s_cselect_b32 s66, 7, 0
    s_mov_b32 s45, 0x3db504f3
    s_mov_b32 s46, 0x3fb8aa3b
    v_mov_b32 v16, 0
    v_mov_b32 v17, 0
    v_mov_b32 v18, 0
    v_mov_b32 v19, 0
    v_mov_b32 v20, 0
    v_mov_b32 v21, 0
    v_mov_b32 v22, 0
    v_mov_b32 v23, 0
    v_mov_b32 v24, 0
    v_mov_b32 v25, 0
    v_mov_b32 v26, 0
    v_mov_b32 v27, 0
    v_mov_b32 v28, 0
    v_mov_b32 v29, 0
    v_mov_b32 v30, 0
    v_mov_b32 v31, 0
    v_mov_b32 v232, 0
    s_mov_b32 s33, 660
    s_mov_b32 s28, 3712
    s_mov_b32 s29, 0
    s_bfm_b32 s32, 14, 0
    s_movk_i32 s67, -35
    s_mov_b32 s64, 0x11111111
    s_mov_b32 s65, 0x11111111
    s_cselect_b64 exec, 0, -1
    s_cbranch_scc1 L_p0
    s_waitcnt vmcnt(5)
    buffer_load_dwordx4 v[64:67], v4, s[36:39], s54 offen nt
    s_waitcnt vmcnt(5)
    buffer_load_dwordx4 v[68:71], v4, s[36:39], s55 offen nt
    s_waitcnt vmcnt(5)
    buffer_load_dwordx4 v[72:75], v4, s[36:39], s56 offen nt
    s_waitcnt vmcnt(5)
    buffer_load_dwordx4 v[76:79], v4, s[36:39], s57 offen nt
    s_waitcnt vmcnt(5)
    buffer_load_dwordx4 v[80:83], v4, s[36:39], s58 offen nt
    s_waitcnt vmcnt(5)
    buffer_load_dwordx4 v[84:87], v4, s[36:39], s59 offen nt
    s_waitcnt vmcnt(5)
    buffer_load_dwordx4 v[88:91], v4, s[36:39], s60 offen nt
    s_waitcnt vmcnt(5)
    buffer_load_dwordx4 v[92:95], v4, s[36:39], s61 offen nt
    s_waitcnt vmcnt(5)
    buffer_load_dwordx4 v[96:99], v4, s[36:39], s62 offen nt
    s_waitcnt vmcnt(5)
    buffer_load_dwordx4 v[100:103], v4, s[36:39], s63 offen nt
    s_waitcnt vmcnt(5)
    buffer_load_dwordx4 v[104:107], v3, s[36:39], s48 offen nt
    s_waitcnt vmcnt(5)
    buffer_load_dwordx4 v[108:111], v3, s[36:39], s49 offen nt
    s_waitcnt vmcnt(5)
    buffer_load_dwordx4 v[112:115], v3, s[36:39], s50 offen nt
    s_waitcnt vmcnt(5)
    buffer_load_dwordx4 v[116:119], v3, s[36:39], s51 offen nt
    s_waitcnt vmcnt(5)
    buffer_load_dwordx4 v[120:123], v3, s[36:39], s52 offen nt
    s_waitcnt vmcnt(5)
    buffer_load_dwordx4 v[124:127], v3, s[36:39], s53 offen nt
    s_waitcnt vmcnt(5)
    buffer_load_dwordx4 v[128:131], v3, s[36:39], s54 offen nt
    s_waitcnt vmcnt(5)
    buffer_load_dwordx4 v[132:135], v3, s[36:39], s55 offen nt
    s_waitcnt vmcnt(5)
    buffer_load_dwordx4 v[136:139], v3, s[36:39], s56 offen nt
    s_waitcnt vmcnt(5)
    buffer_load_dwordx4 v[140:143], v3, s[36:39], s57 offen nt
    s_waitcnt vmcnt(5)
    buffer_load_dwordx4 v[144:147], v3, s[36:39], s58 offen nt
    s_waitcnt vmcnt(5)
    buffer_load_dwordx4 v[148:151], v3, s[36:39], s59 offen nt
    s_waitcnt vmcnt(5)
    buffer_load_dwordx4 v[152:155], v3, s[36:39], s60 offen nt
    s_waitcnt vmcnt(5)
    buffer_load_dwordx4 v[156:159], v3, s[36:39], s61 offen nt
    s_waitcnt vmcnt(5)
    buffer_load_dwordx4 v[160:163], v3, s[36:39], s62 offen nt
    s_waitcnt vmcnt(5)
    buffer_load_dwordx4 v[164:167], v3, s[36:39], s63 offen nt
    s_waitcnt vmcnt(5)
    buffer_load_dwordx4 v[168:171], v7, s[36:39], s48 offen nt
    s_waitcnt vmcnt(5)
    buffer_load_dwordx4 v[172:175], v7, s[36:39], s49 offen nt
    s_waitcnt vmcnt(5)
    buffer_load_dwordx4 v[176:179], v7, s[36:39], s50 offen nt
    s_waitcnt vmcnt(5)
    buffer_load_dwordx4 v[180:183], v7, s[36:39], s51 offen nt
    s_waitcnt vmcnt(5)
    buffer_load_dwordx4 v[184:187], v7, s[36:39], s52 offen nt
    s_waitcnt vmcnt(5)
    buffer_load_dwordx4 v[188:191], v7, s[36:39], s53 offen nt
    s_waitcnt vmcnt(5)
    buffer_load_dwordx4 v[192:195], v7, s[36:39], s54 offen nt
    s_waitcnt vmcnt(5)
    buffer_load_dwordx4 v[196:199], v7, s[36:39], s55 offen nt
    s_waitcnt vmcnt(5)
    buffer_load_dwordx4 v[200:203], v7, s[36:39], s56 offen nt
    s_waitcnt vmcnt(5)
    buffer_load_dwordx4 v[204:207], v7, s[36:39], s57 offen nt
    s_waitcnt vmcnt(5)
    buffer_load_dwordx4 v[208:211], v7, s[36:39], s58 offen nt
    s_waitcnt vmcnt(5)
    buffer_load_dwordx4 v[212:215], v7, s[36:39], s59 offen nt
    s_waitcnt vmcnt(5)
    buffer_load_dwordx4 v[216:219], v7, s[36:39], s60 offen nt
    s_waitcnt vmcnt(5)
    buffer_load_dwordx4 v[220:223], v7, s[36:39], s61 offen nt
    s_waitcnt vmcnt(5)
    buffer_load_dwordx4 v[224:227], v7, s[36:39], s62 offen nt
    s_waitcnt vmcnt(5)
    buffer_load_dwordx4 v[228:231], v7, s[36:39], s63 offen nt
    s_barrier
    s_lshl_b64 exec, s[64:65], 0
    ds_read_b128 v[16:19], v6 offset:0
    s_lshl_b64 exec, s[64:65], 1
    ds_read_b128 v[20:23], v6 offset:0
    s_lshl_b64 exec, s[64:65], 2
    ds_read_b128 v[24:27], v6 offset:0
    s_lshl_b64 exec, s[64:65], 3
    ds_read_b128 v[28:31], v6 offset:0
    s_mov_b64 exec, -1
    s_waitcnt lgkmcnt(0)
L_p0:
    v_mfma_f32_16x16x32_bf16 v[32:35], v[40:43], v[16:19], 0
    buffer_load_dwordx4 v[40:43], v5, s[40:43], s48 offen nt
    v_mfma_f32_16x16x32_bf16 v[32:35], v[44:47], v[20:23], v[32:35]
    buffer_load_dwordx4 v[44:47], v5, s[40:43], s49 offen nt
    v_mfma_f32_16x16x32_bf16 v[32:35], v[48:51], v[24:27], v[32:35]
    buffer_load_dwordx4 v[48:51], v5, s[40:43], s50 offen nt
    v_mfma_f32_16x16x32_bf16 v[32:35], v[52:55], v[28:31], v[32:35]
    buffer_load_dwordx4 v[52:55], v5, s[40:43], s51 offen nt
    v_mfma_f32_16x16x32_bf16 v[36:39], v[56:59], v[16:19], 0
    buffer_load_dwordx4 v[56:59], v5, s[40:43], s52 offen nt
    v_mfma_f32_16x16x32_bf16 v[36:39], v[60:63], v[20:23], v[36:39]
    s_nop 3
    v_add_f32_dpp v32, v33, v32 row_shl:4 row_mask:0xf bank_mask:1
    buffer_load_dwordx4 v[60:63], v5, s[40:43], s53 offen nt
    v_mfma_f32_16x16x32_bf16 v[36:39], v[64:67], v[24:27], v[36:39]
    v_add_f32_dpp v32, v34, v32 row_shl:8 row_mask:0xf bank_mask:1
    buffer_load_dwordx4 v[64:67], v5, s[40:43], s54 offen nt
    v_mfma_f32_16x16x32_bf16 v[36:39], v[68:71], v[28:31], v[36:39]
    v_add_f32_dpp v0, v35, v32 row_shl:12 row_mask:0xf bank_mask:1
    buffer_load_dwordx4 v[68:71], v5, s[40:43], s55 offen nt
    v_mfma_f32_16x16x32_bf16 v[32:35], v[72:75], v[16:19], 0
    buffer_load_dwordx4 v[72:75], v5, s[40:43], s56 offen nt
    v_mfma_f32_16x16x32_bf16 v[32:35], v[76:79], v[20:23], v[32:35]
    s_nop 2
    v_add_f32_dpp v37, v36, v37 row_shr:4 row_mask:0xf bank_mask:2
    v_mfma_f32_16x16x32_bf16 v[32:35], v[80:83], v[24:27], v[32:35]
    s_nop 0
    v_add_f32_dpp v37, v38, v37 row_shl:4 row_mask:0xf bank_mask:2
    v_mfma_f32_16x16x32_bf16 v[32:35], v[84:87], v[28:31], v[32:35]
    s_nop 0
    v_add_f32_dpp v0, v39, v37 row_shl:8 row_mask:0xf bank_mask:2
    v_mfma_f32_16x16x32_bf16 v[36:39], v[88:91], v[16:19], 0
    v_mfma_f32_16x16x32_bf16 v[36:39], v[92:95], v[20:23], v[36:39]
    s_nop 3
    v_add_f32_dpp v34, v32, v34 row_shr:8 row_mask:0xf bank_mask:4
    v_mfma_f32_16x16x32_bf16 v[36:39], v[96:99], v[24:27], v[36:39]
    s_nop 0
    v_add_f32_dpp v34, v33, v34 row_shr:4 row_mask:0xf bank_mask:4
    v_mfma_f32_16x16x32_bf16 v[36:39], v[100:103], v[28:31], v[36:39]
    s_nop 0
    v_add_f32_dpp v0, v35, v34 row_shl:4 row_mask:0xf bank_mask:4
    v_mfma_f32_16x16x32_bf16 v[32:35], v[104:107], v[16:19], 0
    v_mfma_f32_16x16x32_bf16 v[32:35], v[108:111], v[20:23], v[32:35]
    s_nop 3
    v_add_f32_dpp v39, v36, v39 row_shr:12 row_mask:0xf bank_mask:8
    v_mfma_f32_16x16x32_bf16 v[32:35], v[112:115], v[24:27], v[32:35]
    s_nop 0
    v_add_f32_dpp v39, v37, v39 row_shr:8 row_mask:0xf bank_mask:8
    v_mfma_f32_16x16x32_bf16 v[32:35], v[116:119], v[28:31], v[32:35]
    s_nop 0
    v_add_f32_dpp v0, v38, v39 row_shr:4 row_mask:0xf bank_mask:8
    v_cvt_pk_bf16_f32 v0, 0, v0
    v_mul_f32 v0, s45, v0
    v_cvt_pk_bf16_f32 v14, 0, v0
    v_mfma_f32_16x16x32_bf16 v[36:39], v[120:123], v[16:19], 0
    v_mfma_f32_16x16x32_bf16 v[36:39], v[124:127], v[20:23], v[36:39]
    s_nop 0
    v_add_f32_dpp v32, v33, v32 row_shl:4 row_mask:0xf bank_mask:1
    v_mfma_f32_16x16x32_bf16 v[36:39], v[128:131], v[24:27], v[36:39]
    s_nop 0
    v_add_f32_dpp v32, v34, v32 row_shl:8 row_mask:0xf bank_mask:1
    v_mfma_f32_16x16x32_bf16 v[36:39], v[132:135], v[28:31], v[36:39]
    s_nop 0
    v_add_f32_dpp v0, v35, v32 row_shl:12 row_mask:0xf bank_mask:1
    v_mfma_f32_16x16x32_bf16 v[32:35], v[136:139], v[16:19], 0
    v_mfma_f32_16x16x32_bf16 v[32:35], v[140:143], v[20:23], v[32:35]
    s_nop 3
    v_add_f32_dpp v37, v36, v37 row_shr:4 row_mask:0xf bank_mask:2
    v_mfma_f32_16x16x32_bf16 v[32:35], v[144:147], v[24:27], v[32:35]
    s_nop 0
    v_add_f32_dpp v37, v38, v37 row_shl:4 row_mask:0xf bank_mask:2
    v_mfma_f32_16x16x32_bf16 v[32:35], v[148:151], v[28:31], v[32:35]
    s_nop 0
    v_add_f32_dpp v0, v39, v37 row_shl:8 row_mask:0xf bank_mask:2
    v_mfma_f32_16x16x32_bf16 v[36:39], v[152:155], v[16:19], 0
    v_mfma_f32_16x16x32_bf16 v[36:39], v[156:159], v[20:23], v[36:39]
    s_nop 3
    v_add_f32_dpp v34, v32, v34 row_shr:8 row_mask:0xf bank_mask:4
    v_mfma_f32_16x16x32_bf16 v[36:39], v[160:163], v[24:27], v[36:39]
    s_nop 0
    v_add_f32_dpp v34, v33, v34 row_shr:4 row_mask:0xf bank_mask:4
    v_mfma_f32_16x16x32_bf16 v[36:39], v[164:167], v[28:31], v[36:39]
    s_nop 0
    v_add_f32_dpp v0, v35, v34 row_shl:4 row_mask:0xf bank_mask:4
    v_mfma_f32_16x16x32_bf16 v[32:35], v[168:171], v[16:19], 0
    v_mfma_f32_16x16x32_bf16 v[32:35], v[172:175], v[20:23], v[32:35]
    s_nop 3
    v_add_f32_dpp v39, v36, v39 row_shr:12 row_mask:0xf bank_mask:8
    v_mfma_f32_16x16x32_bf16 v[32:35], v[176:179], v[24:27], v[32:35]
    s_nop 0
    v_add_f32_dpp v39, v37, v39 row_shr:8 row_mask:0xf bank_mask:8
    v_mfma_f32_16x16x32_bf16 v[32:35], v[180:183], v[28:31], v[32:35]
    s_nop 0
    v_add_f32_dpp v0, v38, v39 row_shr:4 row_mask:0xf bank_mask:8
    v_cvt_pk_bf16_f32 v0, 0, v0
    v_mul_f32 v0, s45, v0
    v_cvt_pk_bf16_f32 v15, 0, v0
    v_mfma_f32_16x16x32_bf16 v[36:39], v[184:187], v[16:19], 0
    v_mfma_f32_16x16x32_bf16 v[36:39], v[188:191], v[20:23], v[36:39]
    s_nop 0
    v_add_f32_dpp v32, v33, v32 row_shl:4 row_mask:0xf bank_mask:1
    v_mfma_f32_16x16x32_bf16 v[36:39], v[192:195], v[24:27], v[36:39]
    s_nop 0
    v_add_f32_dpp v32, v34, v32 row_shl:8 row_mask:0xf bank_mask:1
    v_mfma_f32_16x16x32_bf16 v[36:39], v[196:199], v[28:31], v[36:39]
    s_nop 0
    v_add_f32_dpp v0, v35, v32 row_shl:12 row_mask:0xf bank_mask:1
    v_mfma_f32_16x16x32_bf16 v[32:35], v[200:203], v[16:19], 0
    v_mfma_f32_16x16x32_bf16 v[32:35], v[204:207], v[20:23], v[32:35]
    s_nop 3
    v_add_f32_dpp v37, v36, v37 row_shr:4 row_mask:0xf bank_mask:2
    s_waitcnt vmcnt(14)
    v_mfma_f32_16x16x32_bf16 v[32:35], v[208:211], v[24:27], v[32:35]
    v_add_f32_dpp v37, v38, v37 row_shl:4 row_mask:0xf bank_mask:2
    s_waitcnt vmcnt(13)
    v_mfma_f32_16x16x32_bf16 v[32:35], v[212:215], v[28:31], v[32:35]
    v_add_f32_dpp v0, v39, v37 row_shl:8 row_mask:0xf bank_mask:2
    s_waitcnt vmcnt(12)
    v_mfma_f32_16x16x32_bf16 v[36:39], v[216:219], v[16:19], 0
    s_waitcnt vmcnt(11)
    v_mfma_f32_16x16x32_bf16 v[36:39], v[220:223], v[20:23], v[36:39]
    s_nop 2
    v_add_f32_dpp v34, v32, v34 row_shr:8 row_mask:0xf bank_mask:4
    s_waitcnt vmcnt(10)
    v_mfma_f32_16x16x32_bf16 v[36:39], v[224:227], v[24:27], v[36:39]
    v_add_f32_dpp v34, v33, v34 row_shr:4 row_mask:0xf bank_mask:4
    s_waitcnt vmcnt(9)
    v_mfma_f32_16x16x32_bf16 v[36:39], v[228:231], v[28:31], v[36:39]
    v_add_f32_dpp v0, v35, v34 row_shl:4 row_mask:0xf bank_mask:4
    s_branch L_kadv
L_kloop:
    s_memrealtime s[68:69]
    s_bitcmp1_b32 s32, 16
    s_waitcnt vmcnt(8)
    s_cbranch_scc1 L_w1
    s_bitcmp1_b32 s32, 0
    s_waitcnt vmcnt(5)
    s_cbranch_scc1 L_w1
    s_waitcnt vmcnt(3)
L_w1:
    buffer_load_dwordx4 v[76:79], v4, s[36:39], s57 offen nt
    v_mfma_f32_16x16x32_bf16 v[32:35], v[40:43], v[16:19], 0
    s_bitcmp1_b32 s32, 24
    s_waitcnt vmcnt(8)
    s_cbranch_scc1 L_w2
    s_bitcmp1_b32 s32, 8
    s_waitcnt vmcnt(5)
    s_cbranch_scc1 L_w2
    s_waitcnt vmcnt(3)
L_w2:
    buffer_load_dwordx4 v[80:83], v4, s[36:39], s58 offen nt
    v_mfma_f32_16x16x32_bf16 v[32:35], v[44:47], v[20:23], v[32:35]
    s_waitcnt lgkmcnt(0)
    s_sub_u32 s68, s68, s33
    s_sub_u32 s68, s68, s67
    s_movk_i32 s67, 0
    v_mov_b32 v236, s68
    v_mov_b32 v237, s33
    s_add_u32 s33, s33, 220
    ds_write_b64 v232, v[236:237] offset:296
    s_bitcmp1_b32 s32, 20
    s_waitcnt vmcnt(8)
    s_cbranch_scc1 L_w3
    s_bitcmp1_b32 s32, 4
    s_waitcnt vmcnt(5)
    s_cbranch_scc1 L_w3
    s_waitcnt vmcnt(3)
L_w3:
    buffer_load_dwordx4 v[84:87], v4, s[36:39], s59 offen nt
    v_mfma_f32_16x16x32_bf16 v[32:35], v[48:51], v[24:27], v[32:35]
    s_bitcmp1_b32 s32, 28
    s_waitcnt vmcnt(8)
    s_cbranch_scc1 L_w4
    s_bitcmp1_b32 s32, 12
    s_waitcnt vmcnt(5)
    s_cbranch_scc1 L_w4
    s_waitcnt vmcnt(3)
L_w4:
    buffer_load_dwordx4 v[88:91], v4, s[36:39], s60 offen nt
    v_mfma_f32_16x16x32_bf16 v[32:35], v[52:55], v[28:31], v[32:35]
    s_bitcmp1_b32 s32, 18
    s_waitcnt vmcnt(8)
    s_cbranch_scc1 L_w5
    s_bitcmp1_b32 s32, 2
    s_waitcnt vmcnt(5)
    s_cbranch_scc1 L_w5
    s_waitcnt vmcnt(3)
L_w5:
    buffer_load_dwordx4 v[92:95], v4, s[36:39], s61 offen nt
    v_mfma_f32_16x16x32_bf16 v[36:39], v[56:59], v[16:19], 0
    s_bitcmp1_b32 s32, 26
    s_waitcnt vmcnt(8)
    s_cbranch_scc1 L_w6
    s_bitcmp1_b32 s32, 10
    s_waitcnt vmcnt(5)
    s_cbranch_scc1 L_w6
    s_waitcnt vmcnt(3)
L_w6:
    buffer_load_dwordx4 v[96:99], v4, s[36:39], s62 offen nt
    v_mfma_f32_16x16x32_bf16 v[36:39], v[60:63], v[20:23], v[36:39]
    v_add_f32_dpp v32, v33, v32 row_shl:4 row_mask:0xf bank_mask:1
    s_bitcmp1_b32 s32, 22
    s_waitcnt vmcnt(8)
    s_cbranch_scc1 L_w7
    s_bitcmp1_b32 s32, 6
    s_waitcnt vmcnt(5)
    s_cbranch_scc1 L_w7
    s_waitcnt vmcnt(3)
L_w7:
    buffer_load_dwordx4 v[100:103], v4, s[36:39], s63 offen nt
    v_mfma_f32_16x16x32_bf16 v[36:39], v[64:67], v[24:27], v[36:39]
    v_add_f32_dpp v32, v34, v32 row_shl:8 row_mask:0xf bank_mask:1
    s_bitcmp1_b32 s32, 30
    s_waitcnt vmcnt(8)
    s_cbranch_scc1 L_w8
    s_bitcmp1_b32 s32, 14
    s_waitcnt vmcnt(5)
    s_cbranch_scc1 L_w8
    s_waitcnt vmcnt(3)
L_w8:
    buffer_load_dwordx4 v[40:43], v5, s[40:43], s48 offen nt
    v_mfma_f32_16x16x32_bf16 v[36:39], v[68:71], v[28:31], v[36:39]
    v_add_f32_dpp v0, v35, v32 row_shl:12 row_mask:0xf bank_mask:1
    s_bitcmp1_b32 s32, 17
    s_waitcnt vmcnt(8)
    s_cbranch_scc1 L_w9
    s_bitcmp1_b32 s32, 1
    s_waitcnt vmcnt(5)
    s_cbranch_scc1 L_w9
    s_waitcnt vmcnt(3)
L_w9:
    buffer_load_dwordx4 v[44:47], v5, s[40:43], s49 offen nt
    v_mfma_f32_16x16x32_bf16 v[32:35], v[72:75], v[16:19], 0
    ds_read_b64 v[234:235], v232 offset:304
    s_bitcmp1_b32 s32, 25
    s_waitcnt vmcnt(8)
    s_cbranch_scc1 L_w10
    s_bitcmp1_b32 s32, 9
    s_waitcnt vmcnt(5)
    s_cbranch_scc1 L_w10
    s_waitcnt vmcnt(3)
L_w10:
    buffer_load_dwordx4 v[48:51], v5, s[40:43], s50 offen nt
    v_mfma_f32_16x16x32_bf16 v[32:35], v[76:79], v[20:23], v[32:35]
    v_add_f32_dpp v37, v36, v37 row_shr:4 row_mask:0xf bank_mask:2
    s_waitcnt lgkmcnt(0)
    v_readfirstlane_b32 s34, v234
    v_readfirstlane_b32 s35, v235
    s_cmp_lg_u32 s29, 0
    s_cselect_b32 s69, 0, 0
    s_sub_u32 s29, s29, s34
    s_sub_u32 s34, s68, s34
    s_and_b32 s34, s34, s35
    s_and_b32 s69, s69, s35
    s_mul_i32 s69, s69, s29
    s_mul_i32 s34, s34, 24
    s_add_u32 s28, s28, s69
    s_mov_b32 s29, s68
    s_max_i32 s28, s28, 0
    s_min_i32 s28, s28, 8192
    s_add_u32 s34, s34, s28
    s_ashr_i32 s34, s34, 8
    s_max_i32 s34, s34, 0
    s_min_i32 s34, s34, 32
    s_bfm_b64 s[34:35], s34, 0
    s_mov_b32 s32, s34
    s_bitcmp1_b32 s32, 21
    s_waitcnt vmcnt(8)
    s_cbranch_scc1 L_w11
    s_bitcmp1_b32 s32, 5
    s_waitcnt vmcnt(5)
    s_cbranch_scc1 L_w11
    s_waitcnt vmcnt(3)
L_w11:
    buffer_load_dwordx4 v[52:55], v5, s[40:43], s51 offen nt
    v_mfma_f32_16x16x32_bf16 v[32:35], v[80:83], v[24:27], v[32:35]
    v_add_f32_dpp v37, v38, v37 row_shl:4 row_mask:0xf bank_mask:2
    s_bitcmp1_b32 s32, 29
    s_waitcnt vmcnt(8)
    s_cbranch_scc1 L_w12
    s_bitcmp1_b32 s32, 13
    s_waitcnt vmcnt(5)
    s_cbranch_scc1 L_w12
    s_waitcnt vmcnt(3)
L_w12:
    buffer_load_dwordx4 v[56:59], v5, s[40:43], s52 offen nt
    v_mfma_f32_16x16x32_bf16 v[32:35], v[84:87], v[28:31], v[32:35]
    v_add_f32_dpp v0, v39, v37 row_shl:8 row_mask:0xf bank_mask:2
    s_bitcmp1_b32 s32, 19
    s_waitcnt vmcnt(8)
    s_cbranch_scc1 L_w13
    s_bitcmp1_b32 s32, 3
    s_waitcnt vmcnt(5)
    s_cbranch_scc1 L_w13
    s_waitcnt vmcnt(3)
L_w13:
    buffer_load_dwordx4 v[60:63], v5, s[40:43], s53 offen nt
    v_mfma_f32_16x16x32_bf16 v[36:39], v[88:91], v[16:19], 0
    s_bitcmp1_b32 s32, 27
    s_waitcnt vmcnt(8)
    s_cbranch_scc1 L_w14
    s_bitcmp1_b32 s32, 11
    s_waitcnt vmcnt(5)
    s_cbranch_scc1 L_w14
    s_waitcnt vmcnt(3)
L_w14:
    buffer_load_dwordx4 v[64:67], v5, s[40:43], s54 offen nt
    v_mfma_f32_16x16x32_bf16 v[36:39], v[92:95], v[20:23], v[36:39]
    v_add_f32_dpp v34, v32, v34 row_shr:8 row_mask:0xf bank_mask:4
    s_bitcmp1_b32 s32, 23
    s_waitcnt vmcnt(8)
    s_cbranch_scc1 L_w15
    s_bitcmp1_b32 s32, 7
    s_waitcnt vmcnt(5)
    s_cbranch_scc1 L_w15
    s_waitcnt vmcnt(3)
L_w15:
    buffer_load_dwordx4 v[68:71], v5, s[40:43], s55 offen nt
    v_mfma_f32_16x16x32_bf16 v[36:39], v[96:99], v[24:27], v[36:39]
    v_add_f32_dpp v34, v33, v34 row_shr:4 row_mask:0xf bank_mask:4
    s_bitcmp1_b32 s32, 31
    s_waitcnt vmcnt(8)
    s_cbranch_scc1 L_w16
    s_bitcmp1_b32 s32, 15
    s_waitcnt vmcnt(5)
    s_cbranch_scc1 L_w16
    s_waitcnt vmcnt(3)
L_w16:
    buffer_load_dwordx4 v[72:75], v5, s[40:43], s56 offen nt
    v_mfma_f32_16x16x32_bf16 v[36:39], v[100:103], v[28:31], v[36:39]
    v_add_f32_dpp v0, v35, v34 row_shl:4 row_mask:0xf bank_mask:4
L_kadv:
    v_mov_b32 v4, v5
    v_add_u32 v5, 0x10000, v5
    v_mov_b32 v8, v9
    v_mov_b32 v9, v10
    v_mov_b32 v10, v11
    v_mov_b32 v11, v12
    v_mov_b32 v12, v13
    v_mov_b32 v13, v14
    v_mov_b32 v14, v15
    s_add_u32 s44, s44, 1
    v_add_f32_dpp v39, v36, v39 row_shr:12 row_mask:0xf bank_mask:8
    s_nop 1
    v_add_f32_dpp v39, v37, v39 row_shr:8 row_mask:0xf bank_mask:8
    s_nop 1
    v_add_f32_dpp v0, v38, v39 row_shr:4 row_mask:0xf bank_mask:8
    v_cvt_pk_bf16_f32 v0, 0, v0
    v_mul_f32 v0, s45, v0
    v_cvt_pk_bf16_f32 v15, 0, v0
    s_cmp_lg_u32 s44, 7
    s_cbranch_scc1 L_knsw
    s_mov_b32 s40, s8
    s_mov_b32 s41, s9
    v_mov_b32 v5, v2
L_knsw:
    s_cmp_eq_u32 s44, 8
    s_cbranch_scc0 L_kloop
    s_cbranch_execnz L_nb3
    s_barrier
L_nb3:
    s_mov_b32 s36, s8
    s_mov_b32 s37, s9
    s_movk_i32 s67, 30
    v_max3_f32 v6, v8, v9, v10
    v_max3_f32 v7, v11, v12, v13
    v_max3_f32 v6, v6, v14, v15
    v_max_f32 v6, v7, v6
    s_nop 1
    v_max_f32_dpp v6, v6, v6 row_ror:8 row_mask:0xf bank_mask:0xf
    s_nop 1
    v_max_f32_dpp v6, v6, v6 row_ror:4 row_mask:0xf bank_mask:0xf
    s_nop 1
    v_max_f32_dpp v6, v6, v6 row_ror:2 row_mask:0xf bank_mask:0xf
    s_nop 1
    v_max_f32_dpp v6, v6, v6 row_ror:1 row_mask:0xf bank_mask:0xf
    v_mov_b32 v7, v6
    s_nop 1
    v_permlane16_swap_b32 v6, v7
    v_max_f32 v6, v6, v7
    v_mov_b32 v7, v6
    s_nop 1
    v_permlane32_swap_b32 v6, v7
    v_max_f32 v6, v6, v7
    v_sub_f32 v8, v8, v6
    v_sub_f32 v9, v9, v6
    v_sub_f32 v10, v10, v6
    v_sub_f32 v11, v11, v6
    v_sub_f32 v12, v12, v6
    v_sub_f32 v13, v13, v6
    v_sub_f32 v14, v14, v6
    v_sub_f32 v15, v15, v6
    v_mul_f32 v8, s46, v8
    v_mul_f32 v9, s46, v9
    v_mul_f32 v10, s46, v10
    v_mul_f32 v11, s46, v11
    v_mul_f32 v12, s46, v12
    v_mul_f32 v13, s46, v13
    v_mul_f32 v14, s46, v14
    v_mul_f32 v15, s46, v15
    v_exp_f32 v8, v8
    v_exp_f32 v9, v9
    v_exp_f32 v10, v10
    v_exp_f32 v11, v11
    v_exp_f32 v12, v12
    v_exp_f32 v13, v13
    v_exp_f32 v14, v14
    v_exp_f32 v15, v15
    v_mov_b32 v16, 0
    v_mov_b32 v17, 0
    v_mov_b32 v18, 0
    v_mov_b32 v19, 0
    v_mov_b32 v20, 0
    v_mov_b32 v21, 0
    v_mov_b32 v22, 0
    v_mov_b32 v23, 0
    v_add_f32 v7, v8, v9
    v_add_f32 v3, v10, v11
    v_add_f32 v7, v7, v12
    v_add_f32 v3, v3, v13
    v_add_f32 v7, v7, v14
    v_add_f32 v3, v3, v15
    v_add_f32 v7, v7, v3
    v_mul_f32 v6, s46, v6
    v_cvt_pk_bf16_f32 v8, v8, v8
    v_cvt_pk_bf16_f32 v9, v9, v9
    v_cvt_pk_bf16_f32 v10, v10, v10
    v_cvt_pk_bf16_f32 v11, v11, v11
    v_cvt_pk_bf16_f32 v12, v12, v12
    v_cvt_pk_bf16_f32 v13, v13, v13
    v_cvt_pk_bf16_f32 v14, v14, v14
    v_cvt_pk_bf16_f32 v15, v15, v15
    v_and_b32 v3, 3, v1
    v_cmp_gt_u32 vcc, 2, v3
    v_lshlrev_b32 v3, 4, v3
    v_mov_b32 v24, 0xffff
    v_lshlrev_b32 v24, v3, v24
    v_cndmask_b32 v24, 0, v24, vcc
    s_nop 1
    v_and_b32_dpp v16, v8, v24 row_newbcast:0 row_mask:0xf bank_mask:1
    v_and_b32_dpp v17, v8, v24 row_newbcast:0 row_mask:0xf bank_mask:2
    v_and_b32_dpp v18, v8, v24 row_newbcast:0 row_mask:0xf bank_mask:4
    v_and_b32_dpp v19, v8, v24 row_newbcast:0 row_mask:0xf bank_mask:8
    v_add_f32_dpp v7, v7, v7 row_ror:8 row_mask:0xf bank_mask:0xf
    s_nop 1
    v_add_f32_dpp v7, v7, v7 row_ror:4 row_mask:0xf bank_mask:0xf
    s_nop 1
    v_add_f32_dpp v7, v7, v7 row_ror:2 row_mask:0xf bank_mask:0xf
    s_nop 1
    v_add_f32_dpp v7, v7, v7 row_ror:1 row_mask:0xf bank_mask:0xf
    v_mov_b32 v3, v7
    s_nop 1
    v_permlane16_swap_b32 v7, v3
    v_add_f32 v7, v7, v3
    v_mov_b32 v3, v7
    s_nop 1
    v_permlane32_swap_b32 v7, v3
    v_add_f32 v7, v7, v3
    v_mov_b32 v3, s47
    ds_write_b64 v3, v[6:7] offset:256
    v_and_b32 v2, 15, v1
    v_lshlrev_b32 v2, 5, v2
    v_lshrrev_b32 v3, 4, v1
    v_lshl_add_u32 v2, v3, 3, v2
    v_mov_b32 v3, 0
L_vloop:
    s_memrealtime s[68:69]
    s_bitcmp1_b32 s32, 16
    s_waitcnt vmcnt(8)
    s_cbranch_scc1 L_w17
    s_bitcmp1_b32 s32, 0
    s_waitcnt vmcnt(5)
    s_cbranch_scc1 L_w17
    s_waitcnt vmcnt(3)
L_w17:
    buffer_load_dwordx4 v[76:79], v4, s[36:39], s57 offen nt
    v_mfma_f32_16x16x32_bf16 v[20:23], v[16:19], v[40:43], v[20:23]
    v_and_b32_dpp v16, v8, v24 row_newbcast:1 row_mask:0xf bank_mask:1
    v_and_b32_dpp v17, v8, v24 row_newbcast:1 row_mask:0xf bank_mask:2
    v_and_b32_dpp v18, v8, v24 row_newbcast:1 row_mask:0xf bank_mask:4
    v_and_b32_dpp v19, v8, v24 row_newbcast:1 row_mask:0xf bank_mask:8
    s_bitcmp1_b32 s32, 24
    s_waitcnt vmcnt(8)
    s_cbranch_scc1 L_w18
    s_bitcmp1_b32 s32, 8
    s_waitcnt vmcnt(5)
    s_cbranch_scc1 L_w18
    s_waitcnt vmcnt(3)
L_w18:
    buffer_load_dwordx4 v[80:83], v4, s[36:39], s58 offen nt
    v_mfma_f32_16x16x32_bf16 v[20:23], v[16:19], v[44:47], v[20:23]
    v_and_b32_dpp v16, v8, v24 row_newbcast:2 row_mask:0xf bank_mask:1
    v_and_b32_dpp v17, v8, v24 row_newbcast:2 row_mask:0xf bank_mask:2
    v_and_b32_dpp v18, v8, v24 row_newbcast:2 row_mask:0xf bank_mask:4
    v_and_b32_dpp v19, v8, v24 row_newbcast:2 row_mask:0xf bank_mask:8
    s_waitcnt lgkmcnt(0)
    s_sub_u32 s68, s68, s33
    s_sub_u32 s68, s68, s67
    s_movk_i32 s67, 12
    v_mov_b32 v236, s68
    v_mov_b32 v237, s33
    s_add_u32 s33, s33, 220
    ds_write_b64 v232, v[236:237] offset:296
    s_bitcmp1_b32 s32, 20
    s_waitcnt vmcnt(8)
    s_cbranch_scc1 L_w19
    s_bitcmp1_b32 s32, 4
    s_waitcnt vmcnt(5)
    s_cbranch_scc1 L_w19
    s_waitcnt vmcnt(3)
L_w19:
    buffer_load_dwordx4 v[84:87], v4, s[36:39], s59 offen nt
    v_mfma_f32_16x16x32_bf16 v[20:23], v[16:19], v[48:51], v[20:23]
    v_and_b32_dpp v16, v8, v24 row_newbcast:3 row_mask:0xf bank_mask:1
    v_and_b32_dpp v17, v8, v24 row_newbcast:3 row_mask:0xf bank_mask:2
    v_and_b32_dpp v18, v8, v24 row_newbcast:3 row_mask:0xf bank_mask:4
    v_and_b32_dpp v19, v8, v24 row_newbcast:3 row_mask:0xf bank_mask:8
    s_bitcmp1_b32 s32, 28
    s_waitcnt vmcnt(8)
    s_cbranch_scc1 L_w20
    s_bitcmp1_b32 s32, 12
    s_waitcnt vmcnt(5)
    s_cbranch_scc1 L_w20
    s_waitcnt vmcnt(3)
L_w20:
    buffer_load_dwordx4 v[88:91], v4, s[36:39], s60 offen nt
    v_mfma_f32_16x16x32_bf16 v[20:23], v[16:19], v[52:55], v[20:23]
    v_and_b32_dpp v16, v8, v24 row_newbcast:4 row_mask:0xf bank_mask:1
    v_and_b32_dpp v17, v8, v24 row_newbcast:4 row_mask:0xf bank_mask:2
    v_and_b32_dpp v18, v8, v24 row_newbcast:4 row_mask:0xf bank_mask:4
    v_and_b32_dpp v19, v8, v24 row_newbcast:4 row_mask:0xf bank_mask:8
    s_bitcmp1_b32 s32, 18
    s_waitcnt vmcnt(8)
    s_cbranch_scc1 L_w21
    s_bitcmp1_b32 s32, 2
    s_waitcnt vmcnt(5)
    s_cbranch_scc1 L_w21
    s_waitcnt vmcnt(3)
L_w21:
    buffer_load_dwordx4 v[92:95], v4, s[36:39], s61 offen nt
    v_mfma_f32_16x16x32_bf16 v[20:23], v[16:19], v[56:59], v[20:23]
    v_and_b32_dpp v16, v8, v24 row_newbcast:5 row_mask:0xf bank_mask:1
    v_and_b32_dpp v17, v8, v24 row_newbcast:5 row_mask:0xf bank_mask:2
    v_and_b32_dpp v18, v8, v24 row_newbcast:5 row_mask:0xf bank_mask:4
    v_and_b32_dpp v19, v8, v24 row_newbcast:5 row_mask:0xf bank_mask:8
    s_bitcmp1_b32 s32, 26
    s_waitcnt vmcnt(8)
    s_cbranch_scc1 L_w22
    s_bitcmp1_b32 s32, 10
    s_waitcnt vmcnt(5)
    s_cbranch_scc1 L_w22
    s_waitcnt vmcnt(3)
L_w22:
    buffer_load_dwordx4 v[96:99], v4, s[36:39], s62 offen nt
    v_mfma_f32_16x16x32_bf16 v[20:23], v[16:19], v[60:63], v[20:23]
    v_and_b32_dpp v16, v8, v24 row_newbcast:6 row_mask:0xf bank_mask:1
    v_and_b32_dpp v17, v8, v24 row_newbcast:6 row_mask:0xf bank_mask:2
    v_and_b32_dpp v18, v8, v24 row_newbcast:6 row_mask:0xf bank_mask:4
    v_and_b32_dpp v19, v8, v24 row_newbcast:6 row_mask:0xf bank_mask:8
    s_bitcmp1_b32 s32, 22
    s_waitcnt vmcnt(8)
    s_cbranch_scc1 L_w23
    s_bitcmp1_b32 s32, 6
    s_waitcnt vmcnt(5)
    s_cbranch_scc1 L_w23
    s_waitcnt vmcnt(3)
L_w23:
    buffer_load_dwordx4 v[100:103], v4, s[36:39], s63 offen nt
    v_mfma_f32_16x16x32_bf16 v[20:23], v[16:19], v[64:67], v[20:23]
    v_and_b32_dpp v16, v8, v24 row_newbcast:7 row_mask:0xf bank_mask:1
    v_and_b32_dpp v17, v8, v24 row_newbcast:7 row_mask:0xf bank_mask:2
    v_and_b32_dpp v18, v8, v24 row_newbcast:7 row_mask:0xf bank_mask:4
    v_and_b32_dpp v19, v8, v24 row_newbcast:7 row_mask:0xf bank_mask:8
    v_mov_b32 v4, v5
    s_bitcmp1_b32 s32, 30
    s_waitcnt vmcnt(8)
    s_cbranch_scc1 L_w24
    s_bitcmp1_b32 s32, 14
    s_waitcnt vmcnt(5)
    s_cbranch_scc1 L_w24
    s_waitcnt vmcnt(3)
L_w24:
    buffer_load_dwordx4 v[40:43], v5, s[40:43], s48 offen nt
    v_mfma_f32_16x16x32_bf16 v[20:23], v[16:19], v[68:71], v[20:23]
    v_and_b32_dpp v16, v8, v24 row_newbcast:8 row_mask:0xf bank_mask:1
    v_and_b32_dpp v17, v8, v24 row_newbcast:8 row_mask:0xf bank_mask:2
    v_and_b32_dpp v18, v8, v24 row_newbcast:8 row_mask:0xf bank_mask:4
    v_and_b32_dpp v19, v8, v24 row_newbcast:8 row_mask:0xf bank_mask:8
    s_bitcmp1_b32 s32, 17
    s_waitcnt vmcnt(8)
    s_cbranch_scc1 L_w25
    s_bitcmp1_b32 s32, 1
    s_waitcnt vmcnt(5)
    s_cbranch_scc1 L_w25
    s_waitcnt vmcnt(3)
L_w25:
    buffer_load_dwordx4 v[44:47], v5, s[40:43], s49 offen nt
    v_mfma_f32_16x16x32_bf16 v[20:23], v[16:19], v[72:75], v[20:23]
    v_and_b32_dpp v16, v8, v24 row_newbcast:9 row_mask:0xf bank_mask:1
    v_and_b32_dpp v17, v8, v24 row_newbcast:9 row_mask:0xf bank_mask:2
    v_and_b32_dpp v18, v8, v24 row_newbcast:9 row_mask:0xf bank_mask:4
    v_and_b32_dpp v19, v8, v24 row_newbcast:9 row_mask:0xf bank_mask:8
    ds_read_b64 v[234:235], v232 offset:304
    s_bitcmp1_b32 s32, 25
    s_waitcnt vmcnt(8)
    s_cbranch_scc1 L_w26
    s_bitcmp1_b32 s32, 9
    s_waitcnt vmcnt(5)
    s_cbranch_scc1 L_w26
    s_waitcnt vmcnt(3)
L_w26:
    buffer_load_dwordx4 v[48:51], v5, s[40:43], s50 offen nt
    v_mfma_f32_16x16x32_bf16 v[20:23], v[16:19], v[76:79], v[20:23]
    v_and_b32_dpp v16, v8, v24 row_newbcast:10 row_mask:0xf bank_mask:1
    v_and_b32_dpp v17, v8, v24 row_newbcast:10 row_mask:0xf bank_mask:2
    v_and_b32_dpp v18, v8, v24 row_newbcast:10 row_mask:0xf bank_mask:4
    v_and_b32_dpp v19, v8, v24 row_newbcast:10 row_mask:0xf bank_mask:8
    s_waitcnt lgkmcnt(0)
    v_readfirstlane_b32 s34, v234
    v_readfirstlane_b32 s35, v235
    s_cmp_lg_u32 s29, 0
    s_cselect_b32 s69, 0, 0
    s_sub_u32 s29, s29, s34
    s_sub_u32 s34, s68, s34
    s_and_b32 s34, s34, s35
    s_and_b32 s69, s69, s35
    s_mul_i32 s69, s69, s29
    s_mul_i32 s34, s34, 24
    s_add_u32 s28, s28, s69
    s_mov_b32 s29, s68
    s_max_i32 s28, s28, 0
    s_min_i32 s28, s28, 8192
    s_add_u32 s34, s34, s28
    s_ashr_i32 s34, s34, 8
    s_max_i32 s34, s34, 0
    s_min_i32 s34, s34, 32
    s_bfm_b64 s[34:35], s34, 0
    s_mov_b32 s32, s34
    s_bitcmp1_b32 s32, 21
    s_waitcnt vmcnt(8)
    s_cbranch_scc1 L_w27
    s_bitcmp1_b32 s32, 5
    s_waitcnt vmcnt(5)
    s_cbranch_scc1 L_w27
    s_waitcnt vmcnt(3)
L_w27:
    buffer_load_dwordx4 v[52:55], v5, s[40:43], s51 offen nt
    v_mfma_f32_16x16x32_bf16 v[20:23], v[16:19], v[80:83], v[20:23]
    v_and_b32_dpp v16, v8, v24 row_newbcast:11 row_mask:0xf bank_mask:1
    v_and_b32_dpp v17, v8, v24 row_newbcast:11 row_mask:0xf bank_mask:2
    v_and_b32_dpp v18, v8, v24 row_newbcast:11 row_mask:0xf bank_mask:4
    v_and_b32_dpp v19, v8, v24 row_newbcast:11 row_mask:0xf bank_mask:8
    s_bitcmp1_b32 s32, 29
    s_waitcnt vmcnt(8)
    s_cbranch_scc1 L_w28
    s_bitcmp1_b32 s32, 13
    s_waitcnt vmcnt(5)
    s_cbranch_scc1 L_w28
    s_waitcnt vmcnt(3)
L_w28:
    buffer_load_dwordx4 v[56:59], v5, s[40:43], s52 offen nt
    v_mfma_f32_16x16x32_bf16 v[20:23], v[16:19], v[84:87], v[20:23]
    v_and_b32_dpp v16, v8, v24 row_newbcast:12 row_mask:0xf bank_mask:1
    v_and_b32_dpp v17, v8, v24 row_newbcast:12 row_mask:0xf bank_mask:2
    v_and_b32_dpp v18, v8, v24 row_newbcast:12 row_mask:0xf bank_mask:4
    v_and_b32_dpp v19, v8, v24 row_newbcast:12 row_mask:0xf bank_mask:8
    s_bitcmp1_b32 s32, 19
    s_waitcnt vmcnt(8)
    s_cbranch_scc1 L_w29
    s_bitcmp1_b32 s32, 3
    s_waitcnt vmcnt(5)
    s_cbranch_scc1 L_w29
    s_waitcnt vmcnt(3)
L_w29:
    buffer_load_dwordx4 v[60:63], v5, s[40:43], s53 offen nt
    v_mfma_f32_16x16x32_bf16 v[20:23], v[16:19], v[88:91], v[20:23]
    v_and_b32_dpp v16, v8, v24 row_newbcast:13 row_mask:0xf bank_mask:1
    v_and_b32_dpp v17, v8, v24 row_newbcast:13 row_mask:0xf bank_mask:2
    v_and_b32_dpp v18, v8, v24 row_newbcast:13 row_mask:0xf bank_mask:4
    v_and_b32_dpp v19, v8, v24 row_newbcast:13 row_mask:0xf bank_mask:8
    s_bitcmp1_b32 s32, 27
    s_waitcnt vmcnt(8)
    s_cbranch_scc1 L_w30
    s_bitcmp1_b32 s32, 11
    s_waitcnt vmcnt(5)
    s_cbranch_scc1 L_w30
    s_waitcnt vmcnt(3)
L_w30:
    buffer_load_dwordx4 v[64:67], v5, s[40:43], s54 offen nt
    v_mfma_f32_16x16x32_bf16 v[20:23], v[16:19], v[92:95], v[20:23]
    v_and_b32_dpp v16, v8, v24 row_newbcast:14 row_mask:0xf bank_mask:1
    v_and_b32_dpp v17, v8, v24 row_newbcast:14 row_mask:0xf bank_mask:2
    v_and_b32_dpp v18, v8, v24 row_newbcast:14 row_mask:0xf bank_mask:4
    v_and_b32_dpp v19, v8, v24 row_newbcast:14 row_mask:0xf bank_mask:8
    s_bitcmp1_b32 s32, 23
    s_waitcnt vmcnt(8)
    s_cbranch_scc1 L_w31
    s_bitcmp1_b32 s32, 7
    s_waitcnt vmcnt(5)
    s_cbranch_scc1 L_w31
    s_waitcnt vmcnt(3)
L_w31:
    buffer_load_dwordx4 v[68:71], v5, s[40:43], s55 offen nt
    v_mfma_f32_16x16x32_bf16 v[20:23], v[16:19], v[96:99], v[20:23]
    v_and_b32_dpp v16, v8, v24 row_newbcast:15 row_mask:0xf bank_mask:1
    v_and_b32_dpp v17, v8, v24 row_newbcast:15 row_mask:0xf bank_mask:2
    v_and_b32_dpp v18, v8, v24 row_newbcast:15 row_mask:0xf bank_mask:4
    v_and_b32_dpp v19, v8, v24 row_newbcast:15 row_mask:0xf bank_mask:8
    v_mov_b32 v8, v9
    v_mov_b32 v9, v10
    v_mov_b32 v10, v11
    v_mov_b32 v11, v12
    v_mov_b32 v12, v13
    v_mov_b32 v13, v14
    v_mov_b32 v14, v15
    s_bitcmp1_b32 s32, 31
    s_waitcnt vmcnt(8)
    s_cbranch_scc1 L_w32
    s_bitcmp1_b32 s32, 15
    s_waitcnt vmcnt(5)
    s_cbranch_scc1 L_w32
    s_waitcnt vmcnt(3)
L_w32:
    buffer_load_dwordx4 v[72:75], v5, s[40:43], s56 offen nt
    v_mfma_f32_16x16x32_bf16 v[20:23], v[16:19], v[100:103], v[20:23]
    v_and_b32_dpp v16, v8, v24 row_newbcast:0 row_mask:0xf bank_mask:1
    v_and_b32_dpp v17, v8, v24 row_newbcast:0 row_mask:0xf bank_mask:2
    v_and_b32_dpp v18, v8, v24 row_newbcast:0 row_mask:0xf bank_mask:4
    v_and_b32_dpp v19, v8, v24 row_newbcast:0 row_mask:0xf bank_mask:8
    v_add_u32 v5, 0x10000, v5
    s_add_u32 s66, s66, 1
    s_cmp_lt_u32 s66, 7
    s_cbranch_scc1 L_vloop
    ds_read_b128 v[104:107], v3 offset:256
    ds_read_b128 v[108:111], v3 offset:272
    s_bitcmp1_b32 s32, 16
    s_waitcnt vmcnt(8)
    s_cbranch_scc1 L_w33
    s_bitcmp1_b32 s32, 0
    s_waitcnt vmcnt(5)
    s_cbranch_scc1 L_w33
    s_waitcnt vmcnt(3)
L_w33:
    buffer_load_dwordx4 v[76:79], v4, s[36:39], s57 offen nt
    v_mfma_f32_16x16x32_bf16 v[20:23], v[16:19], v[40:43], v[20:23]
    v_and_b32_dpp v16, v8, v24 row_newbcast:1 row_mask:0xf bank_mask:1
    v_and_b32_dpp v17, v8, v24 row_newbcast:1 row_mask:0xf bank_mask:2
    v_and_b32_dpp v18, v8, v24 row_newbcast:1 row_mask:0xf bank_mask:4
    v_and_b32_dpp v19, v8, v24 row_newbcast:1 row_mask:0xf bank_mask:8
    s_bitcmp1_b32 s32, 24
    s_waitcnt vmcnt(8)
    s_cbranch_scc1 L_w34
    s_bitcmp1_b32 s32, 8
    s_waitcnt vmcnt(5)
    s_cbranch_scc1 L_w34
    s_waitcnt vmcnt(3)
L_w34:
    buffer_load_dwordx4 v[80:83], v4, s[36:39], s58 offen nt
    v_mfma_f32_16x16x32_bf16 v[20:23], v[16:19], v[44:47], v[20:23]
    v_and_b32_dpp v16, v8, v24 row_newbcast:2 row_mask:0xf bank_mask:1
    v_and_b32_dpp v17, v8, v24 row_newbcast:2 row_mask:0xf bank_mask:2
    v_and_b32_dpp v18, v8, v24 row_newbcast:2 row_mask:0xf bank_mask:4
    v_and_b32_dpp v19, v8, v24 row_newbcast:2 row_mask:0xf bank_mask:8
    s_bitcmp1_b32 s32, 20
    s_waitcnt vmcnt(8)
    s_cbranch_scc1 L_w35
    s_bitcmp1_b32 s32, 4
    s_waitcnt vmcnt(5)
    s_cbranch_scc1 L_w35
    s_waitcnt vmcnt(3)
L_w35:
    buffer_load_dwordx4 v[84:87], v4, s[36:39], s59 offen nt
    v_mfma_f32_16x16x32_bf16 v[20:23], v[16:19], v[48:51], v[20:23]
    v_and_b32_dpp v16, v8, v24 row_newbcast:3 row_mask:0xf bank_mask:1
    v_and_b32_dpp v17, v8, v24 row_newbcast:3 row_mask:0xf bank_mask:2
    v_and_b32_dpp v18, v8, v24 row_newbcast:3 row_mask:0xf bank_mask:4
    v_and_b32_dpp v19, v8, v24 row_newbcast:3 row_mask:0xf bank_mask:8
    s_waitcnt lgkmcnt(0)
    v_max3_f32 v112, v104, v106, v108
    v_min3_f32 v113, v105, v107, v109
    v_max_f32 v112, v112, v110
    v_min_f32 v113, v113, v111
    v_sub_f32 v114, v6, v112
    v_cmp_gt_f32 s[30:31], 0, v113
    v_exp_f32 v114, v114
    s_nop 0
    v_mul_f32 v115, v7, v114
    s_bitcmp1_b32 s32, 28
    s_waitcnt vmcnt(8)
    s_cbranch_scc1 L_w36
    s_bitcmp1_b32 s32, 12
    s_waitcnt vmcnt(5)
    s_cbranch_scc1 L_w36
    s_waitcnt vmcnt(3)
L_w36:
    buffer_load_dwordx4 v[88:91], v4, s[36:39], s60 offen nt
    v_mfma_f32_16x16x32_bf16 v[20:23], v[16:19], v[52:55], v[20:23]
    v_and_b32_dpp v16, v8, v24 row_newbcast:4 row_mask:0xf bank_mask:1
    v_and_b32_dpp v17, v8, v24 row_newbcast:4 row_mask:0xf bank_mask:2
    v_and_b32_dpp v18, v8, v24 row_newbcast:4 row_mask:0xf bank_mask:4
    v_and_b32_dpp v19, v8, v24 row_newbcast:4 row_mask:0xf bank_mask:8
    s_bitcmp1_b32 s32, 18
    s_waitcnt vmcnt(8)
    s_cbranch_scc1 L_w37
    s_bitcmp1_b32 s32, 2
    s_waitcnt vmcnt(5)
    s_cbranch_scc1 L_w37
    s_waitcnt vmcnt(3)
L_w37:
    buffer_load_dwordx4 v[92:95], v4, s[36:39], s61 offen nt
    v_mfma_f32_16x16x32_bf16 v[20:23], v[16:19], v[56:59], v[20:23]
    v_and_b32_dpp v16, v8, v24 row_newbcast:5 row_mask:0xf bank_mask:1
    v_and_b32_dpp v17, v8, v24 row_newbcast:5 row_mask:0xf bank_mask:2
    v_and_b32_dpp v18, v8, v24 row_newbcast:5 row_mask:0xf bank_mask:4
    v_and_b32_dpp v19, v8, v24 row_newbcast:5 row_mask:0xf bank_mask:8
    s_bitcmp1_b32 s32, 26
    s_waitcnt vmcnt(8)
    s_cbranch_scc1 L_w38
    s_bitcmp1_b32 s32, 10
    s_waitcnt vmcnt(5)
    s_cbranch_scc1 L_w38
    s_waitcnt vmcnt(3)
L_w38:
    buffer_load_dwordx4 v[96:99], v4, s[36:39], s62 offen nt
    v_mfma_f32_16x16x32_bf16 v[20:23], v[16:19], v[60:63], v[20:23]
    v_and_b32_dpp v16, v8, v24 row_newbcast:6 row_mask:0xf bank_mask:1
    v_and_b32_dpp v17, v8, v24 row_newbcast:6 row_mask:0xf bank_mask:2
    v_and_b32_dpp v18, v8, v24 row_newbcast:6 row_mask:0xf bank_mask:4
    v_and_b32_dpp v19, v8, v24 row_newbcast:6 row_mask:0xf bank_mask:8
    s_bitcmp1_b32 s32, 22
    s_waitcnt vmcnt(8)
    s_cbranch_scc1 L_w39
    s_bitcmp1_b32 s32, 6
    s_waitcnt vmcnt(5)
    s_cbranch_scc1 L_w39
    s_waitcnt vmcnt(3)
L_w39:
    buffer_load_dwordx4 v[100:103], v4, s[36:39], s63 offen nt
    s_cbranch_execz L_ntr
    s_barrier
L_ntr:
    v_mfma_f32_16x16x32_bf16 v[20:23], v[16:19], v[64:67], v[20:23]
    v_and_b32_dpp v16, v8, v24 row_newbcast:7 row_mask:0xf bank_mask:1
    v_and_b32_dpp v17, v8, v24 row_newbcast:7 row_mask:0xf bank_mask:2
    v_and_b32_dpp v18, v8, v24 row_newbcast:7 row_mask:0xf bank_mask:4
    v_and_b32_dpp v19, v8, v24 row_newbcast:7 row_mask:0xf bank_mask:8
    s_waitcnt vmcnt(8)
    s_nop 0
    v_mfma_f32_16x16x32_bf16 v[20:23], v[16:19], v[68:71], v[20:23]
    v_and_b32_dpp v16, v8, v24 row_newbcast:8 row_mask:0xf bank_mask:1
    v_and_b32_dpp v17, v8, v24 row_newbcast:8 row_mask:0xf bank_mask:2
    v_and_b32_dpp v18, v8, v24 row_newbcast:8 row_mask:0xf bank_mask:4
    v_and_b32_dpp v19, v8, v24 row_newbcast:8 row_mask:0xf bank_mask:8
    s_waitcnt vmcnt(7)
    s_nop 0
    v_mfma_f32_16x16x32_bf16 v[20:23], v[16:19], v[72:75], v[20:23]
    v_and_b32_dpp v16, v8, v24 row_newbcast:9 row_mask:0xf bank_mask:1
    v_and_b32_dpp v17, v8, v24 row_newbcast:9 row_mask:0xf bank_mask:2
    v_and_b32_dpp v18, v8, v24 row_newbcast:9 row_mask:0xf bank_mask:4
    v_and_b32_dpp v19, v8, v24 row_newbcast:9 row_mask:0xf bank_mask:8
    s_waitcnt vmcnt(6)
    s_nop 0
    v_mfma_f32_16x16x32_bf16 v[20:23], v[16:19], v[76:79], v[20:23]
    v_and_b32_dpp v16, v8, v24 row_newbcast:10 row_mask:0xf bank_mask:1
    v_and_b32_dpp v17, v8, v24 row_newbcast:10 row_mask:0xf bank_mask:2
    v_and_b32_dpp v18, v8, v24 row_newbcast:10 row_mask:0xf bank_mask:4
    v_and_b32_dpp v19, v8, v24 row_newbcast:10 row_mask:0xf bank_mask:8
    s_waitcnt vmcnt(5)
    s_nop 0
    v_mfma_f32_16x16x32_bf16 v[20:23], v[16:19], v[80:83], v[20:23]
    v_and_b32_dpp v16, v8, v24 row_newbcast:11 row_mask:0xf bank_mask:1
    v_and_b32_dpp v17, v8, v24 row_newbcast:11 row_mask:0xf bank_mask:2
    v_and_b32_dpp v18, v8, v24 row_newbcast:11 row_mask:0xf bank_mask:4
    v_and_b32_dpp v19, v8, v24 row_newbcast:11 row_mask:0xf bank_mask:8
    s_waitcnt vmcnt(4)
    s_nop 0
    v_mfma_f32_16x16x32_bf16 v[20:23], v[16:19], v[84:87], v[20:23]
    v_and_b32_dpp v16, v8, v24 row_newbcast:12 row_mask:0xf bank_mask:1
    v_and_b32_dpp v17, v8, v24 row_newbcast:12 row_mask:0xf bank_mask:2
    v_and_b32_dpp v18, v8, v24 row_newbcast:12 row_mask:0xf bank_mask:4
    v_and_b32_dpp v19, v8, v24 row_newbcast:12 row_mask:0xf bank_mask:8
    s_waitcnt vmcnt(3)
    s_nop 0
    v_mfma_f32_16x16x32_bf16 v[20:23], v[16:19], v[88:91], v[20:23]
    v_and_b32_dpp v16, v8, v24 row_newbcast:13 row_mask:0xf bank_mask:1
    v_and_b32_dpp v17, v8, v24 row_newbcast:13 row_mask:0xf bank_mask:2
    v_and_b32_dpp v18, v8, v24 row_newbcast:13 row_mask:0xf bank_mask:4
    v_and_b32_dpp v19, v8, v24 row_newbcast:13 row_mask:0xf bank_mask:8
    s_waitcnt vmcnt(2)
    s_nop 0
    v_mfma_f32_16x16x32_bf16 v[20:23], v[16:19], v[92:95], v[20:23]
    v_and_b32_dpp v16, v8, v24 row_newbcast:14 row_mask:0xf bank_mask:1
    v_and_b32_dpp v17, v8, v24 row_newbcast:14 row_mask:0xf bank_mask:2
    v_and_b32_dpp v18, v8, v24 row_newbcast:14 row_mask:0xf bank_mask:4
    v_and_b32_dpp v19, v8, v24 row_newbcast:14 row_mask:0xf bank_mask:8
    s_waitcnt vmcnt(1)
    s_nop 0
    v_mfma_f32_16x16x32_bf16 v[20:23], v[16:19], v[96:99], v[20:23]
    v_and_b32_dpp v16, v8, v24 row_newbcast:15 row_mask:0xf bank_mask:1
    v_and_b32_dpp v17, v8, v24 row_newbcast:15 row_mask:0xf bank_mask:2
    v_and_b32_dpp v18, v8, v24 row_newbcast:15 row_mask:0xf bank_mask:4
    v_and_b32_dpp v19, v8, v24 row_newbcast:15 row_mask:0xf bank_mask:8
    s_waitcnt vmcnt(0)
    s_nop 0
    v_mfma_f32_16x16x32_bf16 v[20:23], v[16:19], v[100:103], v[20:23]
L_mlchk:
    s_cmp_lg_u64 s[30:31], 0
    s_cbranch_scc1 L_mlslow
    s_nop 5
    v_mul_f32 v20, v20, v114
    v_mul_f32 v21, v21, v114
    ds_add_f32 v2, v20 offset:512
    ds_add_f32 v2, v21 offset:516
    s_and_b64 exec, exec, 1
    ds_add_f32 v3, v115 offset:292
    ds_write_b32 v3, v112 offset:288
    s_cbranch_execz L_dryret
    s_waitcnt lgkmcnt(0)
    s_barrier
    s_endpgm
L_mlslow:
    ds_read_b128 v[104:107], v3 offset:256
    ds_read_b128 v[108:111], v3 offset:272
    s_waitcnt lgkmcnt(0)
    v_max3_f32 v112, v104, v106, v108
    v_min3_f32 v113, v105, v107, v109
    v_max_f32 v112, v112, v110
    v_min_f32 v113, v113, v111
    v_sub_f32 v114, v6, v112
    v_cmp_gt_f32 s[30:31], 0, v113
    v_exp_f32 v114, v114
    s_nop 0
    v_mul_f32 v115, v7, v114
    s_branch L_mlchk
L_dryret:
    s_mov_b64 exec, -1
L_helper:
    s_lshr_b32 s28, s2, 3
    s_and_b32 s29, s2, 7
    s_mul_i32 s34, s29, 80
    v_lshrrev_b32 v8, 4, v1
    v_and_b32 v9, 15, v1
    v_add_u32 v12, s34, v8
    v_lshlrev_b32 v7, 2, v1
    s_mov_b32 s38, 1280
    s_mov_b32 s39, 0x20000
    s_mov_b32 s59, 0x20000
    s_cmp_eq_u32 s3, 0
    s_cbranch_scc0 L_nh0
    v_lshlrev_b32 v13, 13, v12
    v_lshl_add_u32 v13, v9, 4, v13
    s_lshl_b32 s44, s28, 8
    s_mov_b32 s58, 5242880
    s_waitcnt lgkmcnt(0)
    s_mov_b32 s36, s4
    s_mov_b32 s37, s5
    s_mov_b32 s56, s10
    s_mov_b32 s57, s11
    buffer_load_dword v2, v7, s[36:39], 0 offen offset:0
    buffer_load_dword v3, v7, s[36:39], 0 offen offset:256
    buffer_load_dword v4, v7, s[36:39], 0 offen offset:512
    buffer_load_dword v5, v7, s[36:39], 0 offen offset:768
    buffer_load_dword v6, v7, s[36:39], 0 offen offset:1024
    buffer_load_dwordx4 v[80:83], v13, s[56:59], s44 offen nt
    s_add_u32 s44, s44, 32768
    buffer_load_dwordx4 v[84:87], v13, s[56:59], s44 offen nt
    s_add_u32 s44, s44, 32768
    buffer_load_dwordx4 v[88:91], v13, s[56:59], s44 offen nt
    s_add_u32 s44, s44, 32768
    buffer_load_dwordx4 v[92:95], v13, s[56:59], s44 offen nt
    s_add_u32 s44, s44, 32768
    buffer_load_dwordx4 v[96:99], v13, s[56:59], s44 offen nt
    s_add_u32 s44, s44, 32768
    buffer_load_dwordx4 v[100:103], v13, s[56:59], s44 offen nt
    s_add_u32 s44, s44, 32768
    buffer_load_dwordx4 v[104:107], v13, s[56:59], s44 offen nt
    s_add_u32 s44, s44, 32768
    buffer_load_dwordx4 v[108:111], v13, s[56:59], s44 offen nt
    s_add_u32 s44, s44, 32768
    buffer_load_dwordx4 v[112:115], v13, s[56:59], s44 offen nt
    s_add_u32 s44, s44, 32768
    buffer_load_dwordx4 v[116:119], v13, s[56:59], s44 offen nt
    s_add_u32 s44, s44, 32768
    buffer_load_dwordx4 v[120:123], v13, s[56:59], s44 offen nt
    s_add_u32 s44, s44, 32768
    buffer_load_dwordx4 v[124:127], v13, s[56:59], s44 offen nt
    s_add_u32 s44, s44, 32768
    buffer_load_dwordx4 v[128:131], v13, s[56:59], s44 offen nt
    s_add_u32 s44, s44, 32768
    buffer_load_dwordx4 v[132:135], v13, s[56:59], s44 offen nt
    s_add_u32 s44, s44, 32768
    buffer_load_dwordx4 v[136:139], v13, s[56:59], s44 offen nt
    s_add_u32 s44, s44, 32768
    buffer_load_dwordx4 v[140:143], v13, s[56:59], s44 offen nt
    s_add_u32 s44, s44, 32768
    buffer_load_dwordx4 v[144:147], v13, s[56:59], s44 offen nt
    s_add_u32 s44, s44, 32768
    buffer_load_dwordx4 v[148:151], v13, s[56:59], s44 offen nt
    s_add_u32 s44, s44, 32768
    buffer_load_dwordx4 v[152:155], v13, s[56:59], s44 offen nt
    s_add_u32 s44, s44, 32768
    buffer_load_dwordx4 v[156:159], v13, s[56:59], s44 offen nt
L_hset:
    s_load_dword s33, s[26:27], 983040
    v_lshl_add_u32 v12, v9, 2, v12
    v_lshlrev_b32 v12, 1, v12
    v_lshlrev_b32 v57, 3, v1
    v_lshlrev_b32 v31, 4, v1
    v_mov_b32 v30, 0
    v_bfrev_b32 v27, 1
    s_mov_b32 s36, s4
    s_mov_b32 s37, s5
    s_mov_b32 s40, s26
    s_mov_b32 s41, s27
    s_mov_b32 s42, 4194304
    s_mov_b32 s43, 0x20000
    s_and_b32 s35, s3, 1
    s_lshl_b32 s35, s35, 18
    s_lshl_b32 s44, s2, 10
    s_add_u32 s44, s44, s35
    s_lshl_b32 s45, s28, 13
    s_add_u32 s45, s45, s35
    s_add_u32 s47, s45, 4096
    s_add_u32 s31, s28, s29
    s_and_b32 s31, s31, 7
    v_mov_b32 v16, 0
    v_mov_b32 v17, 0
    v_mov_b32 v18, 0
    v_mov_b32 v19, 0
    v_mov_b32 v20, 0
    v_mov_b32 v21, 0
    v_mov_b32 v22, 0
    v_mov_b32 v23, 0
    v_and_b32 v10, 3, v1
    v_cmp_gt_u32 vcc, 2, v10
    v_lshlrev_b32 v10, 4, v10
    v_mov_b32 v24, 0xffff
    v_lshlrev_b32 v24, v10, v24
    v_cndmask_b32 v24, 0, v24, vcc
    v_lshlrev_b32 v14, 4, v9
    v_lshl_add_u32 v14, v8, 2, v14
    s_mov_b32 s30, 0
    s_cmp_ge_u32 s3, 2
    s_cbranch_scc1 L_h23
    s_cmp_lt_u32 s28, 27
    s_cselect_b32 s35, 2, 1
    s_cmp_eq_u32 s3, s35
    s_cbranch_scc1 L_b1
L_ln:
    s_waitcnt vmcnt(20)
    v_lshlrev_b32 v32, 16, v2
    v_and_b32 v33, 0xffff0000, v2
    v_lshlrev_b32 v34, 16, v3
    v_and_b32 v35, 0xffff0000, v3
    v_lshlrev_b32 v36, 16, v4
    v_and_b32 v37, 0xffff0000, v4
    v_lshlrev_b32 v38, 16, v5
    v_and_b32 v39, 0xffff0000, v5
    v_lshlrev_b32 v40, 16, v6
    v_and_b32 v41, 0xffff0000, v6
    v_add_f32 v2, v32, v33
    v_add_f32 v3, v34, v35
    v_add_f32 v2, v2, v36
    v_add_f32 v3, v3, v37
    v_add_f32 v2, v2, v38
    v_add_f32 v3, v3, v39
    v_add_f32 v2, v2, v40
    v_add_f32 v3, v3, v41
    v_add_f32 v2, v2, v3
    s_nop 1
    v_add_f32_dpp v2, v2, v2 row_ror:8 row_mask:0xf bank_mask:0xf
    s_nop 1
    v_add_f32_dpp v2, v2, v2 row_ror:4 row_mask:0xf bank_mask:0xf
    s_nop 1
    v_add_f32_dpp v2, v2, v2 row_ror:2 row_mask:0xf bank_mask:0xf
    s_nop 1
    v_add_f32_dpp v2, v2, v2 row_ror:1 row_mask:0xf bank_mask:0xf
    v_mov_b32 v3, v2
    s_nop 1
    v_permlane16_swap_b32 v2, v3
    v_add_f32 v2, v2, v3
    v_mov_b32 v3, v2
    s_nop 1
    v_permlane32_swap_b32 v2, v3
    v_add_f32 v2, v2, v3
    s_mov_b32 s46, 0x3acccccd
    v_mul_f32 v2, s46, v2
    v_sub_f32 v4, v32, v2
    v_mul_f32 v3, v4, v4
    v_sub_f32 v4, v33, v2
    v_fmac_f32 v3, v4, v4
    v_sub_f32 v4, v34, v2
    v_fmac_f32 v3, v4, v4
    v_sub_f32 v4, v35, v2
    v_fmac_f32 v3, v4, v4
    v_sub_f32 v4, v36, v2
    v_fmac_f32 v3, v4, v4
    v_sub_f32 v4, v37, v2
    v_fmac_f32 v3, v4, v4
    v_sub_f32 v4, v38, v2
    v_fmac_f32 v3, v4, v4
    v_sub_f32 v4, v39, v2
    v_fmac_f32 v3, v4, v4
    v_sub_f32 v4, v40, v2
    v_fmac_f32 v3, v4, v4
    v_sub_f32 v4, v41, v2
    v_fmac_f32 v3, v4, v4
    s_nop 1
    v_add_f32_dpp v3, v3, v3 row_ror:8 row_mask:0xf bank_mask:0xf
    s_nop 1
    v_add_f32_dpp v3, v3, v3 row_ror:4 row_mask:0xf bank_mask:0xf
    s_nop 1
    v_add_f32_dpp v3, v3, v3 row_ror:2 row_mask:0xf bank_mask:0xf
    s_nop 1
    v_add_f32_dpp v3, v3, v3 row_ror:1 row_mask:0xf bank_mask:0xf
    v_mov_b32 v4, v3
    s_nop 1
    v_permlane16_swap_b32 v3, v4
    v_add_f32 v3, v3, v4
    v_mov_b32 v4, v3
    s_nop 1
    v_permlane32_swap_b32 v3, v4
    v_add_f32 v3, v3, v4
    v_mul_f32 v3, s46, v3
    v_cvt_pk_bf16_f32 v2, 0, v2
    v_cvt_pk_bf16_f32 v3, 0, v3
    v_add_f32 v3, 0x3727c5ac, v3
    v_cvt_pk_bf16_f32 v3, 0, v3
    v_sqrt_f32 v3, v3
    v_sub_f32 v32, v32, v2
    v_sub_f32 v33, v33, v2
    v_sub_f32 v34, v34, v2
    v_sub_f32 v35, v35, v2
    v_sub_f32 v36, v36, v2
    v_sub_f32 v37, v37, v2
    v_sub_f32 v38, v38, v2
    v_sub_f32 v39, v39, v2
    v_sub_f32 v40, v40, v2
    v_sub_f32 v41, v41, v2
    v_cvt_pk_bf16_f32 v3, 0, v3
    v_rcp_f32 v3, v3
    v_cvt_pk_bf16_f32 v32, 0, v32
    v_cvt_pk_bf16_f32 v33, 0, v33
    v_cvt_pk_bf16_f32 v34, 0, v34
    v_cvt_pk_bf16_f32 v35, 0, v35
    v_cvt_pk_bf16_f32 v36, 0, v36
    v_cvt_pk_bf16_f32 v37, 0, v37
    v_cvt_pk_bf16_f32 v38, 0, v38
    v_cvt_pk_bf16_f32 v39, 0, v39
    v_cvt_pk_bf16_f32 v40, 0, v40
    v_cvt_pk_bf16_f32 v41, 0, v41
    v_mul_f32 v32, v32, v3
    v_mul_f32 v33, v33, v3
    v_mul_f32 v34, v34, v3
    v_mul_f32 v35, v35, v3
    v_mul_f32 v36, v36, v3
    v_mul_f32 v37, v37, v3
    v_mul_f32 v38, v38, v3
    v_mul_f32 v39, v39, v3
    v_mul_f32 v40, v40, v3
    v_mul_f32 v41, v41, v3
    v_cvt_pk_bf16_f32 v32, v32, v33
    ds_write_b32 v7, v32 offset:3072
    v_cvt_pk_bf16_f32 v33, v34, v35
    ds_write_b32 v7, v33 offset:3328
    v_cvt_pk_bf16_f32 v34, v36, v37
    ds_write_b32 v7, v34 offset:3584
    v_cvt_pk_bf16_f32 v35, v38, v39
    ds_write_b32 v7, v35 offset:3840
    v_cvt_pk_bf16_f32 v36, v40, v41
    ds_write_b32 v7, v36 offset:4096
    ds_read_u16 v5, v12 offset:3072
    ds_read_u16 v6, v12 offset:3200
    s_waitcnt lgkmcnt(0)
    v_lshl_or_b32 v5, v5, 16, v5
    v_lshl_or_b32 v6, v6, 16, v6
    s_add_u32 s32, s33, 0x9e3779b9
    v_mov_b32 v26, s32
    v_and_b32 v64, 1, v1
    v_lshlrev_b32 v64, 4, v64
    v_bfe_u32 v64, v26, v64, 16
    v_lshrrev_b32 v65, 8, v64
    v_mov_b32 v66, 0xff
    v_mov_b32 v67, 0x0c0c0400
    v_and_b32_dpp v16, v5, v24 row_newbcast:0 row_mask:0xf bank_mask:1
    v_and_b32_dpp v17, v5, v24 row_newbcast:0 row_mask:0xf bank_mask:2
    v_and_b32_dpp v18, v5, v24 row_newbcast:0 row_mask:0xf bank_mask:4
    v_and_b32_dpp v19, v5, v24 row_newbcast:0 row_mask:0xf bank_mask:8
    s_waitcnt vmcnt(19)
    s_nop 0
    v_mfma_f32_16x16x32_bf16 v[20:23], v[16:19], v[80:83], v[20:23]
    v_and_b32_dpp v16, v5, v24 row_newbcast:1 row_mask:0xf bank_mask:1
    v_and_b32_dpp v17, v5, v24 row_newbcast:1 row_mask:0xf bank_mask:2
    v_and_b32_dpp v18, v5, v24 row_newbcast:1 row_mask:0xf bank_mask:4
    v_and_b32_dpp v19, v5, v24 row_newbcast:1 row_mask:0xf bank_mask:8
    s_waitcnt vmcnt(18)
    s_nop 0
    v_mfma_f32_16x16x32_bf16 v[20:23], v[16:19], v[84:87], v[20:23]
    v_and_b32_dpp v16, v5, v24 row_newbcast:2 row_mask:0xf bank_mask:1
    v_and_b32_dpp v17, v5, v24 row_newbcast:2 row_mask:0xf bank_mask:2
    v_and_b32_dpp v18, v5, v24 row_newbcast:2 row_mask:0xf bank_mask:4
    v_and_b32_dpp v19, v5, v24 row_newbcast:2 row_mask:0xf bank_mask:8
    s_waitcnt vmcnt(17)
    s_nop 0
    v_mfma_f32_16x16x32_bf16 v[20:23], v[16:19], v[88:91], v[20:23]
    v_and_b32_dpp v16, v5, v24 row_newbcast:3 row_mask:0xf bank_mask:1
    v_and_b32_dpp v17, v5, v24 row_newbcast:3 row_mask:0xf bank_mask:2
    v_and_b32_dpp v18, v5, v24 row_newbcast:3 row_mask:0xf bank_mask:4
    v_and_b32_dpp v19, v5, v24 row_newbcast:3 row_mask:0xf bank_mask:8
    s_waitcnt vmcnt(16)
    s_nop 0
    v_mfma_f32_16x16x32_bf16 v[20:23], v[16:19], v[92:95], v[20:23]
    v_and_b32_dpp v16, v5, v24 row_newbcast:4 row_mask:0xf bank_mask:1
    v_and_b32_dpp v17, v5, v24 row_newbcast:4 row_mask:0xf bank_mask:2
    v_and_b32_dpp v18, v5, v24 row_newbcast:4 row_mask:0xf bank_mask:4
    v_and_b32_dpp v19, v5, v24 row_newbcast:4 row_mask:0xf bank_mask:8
    s_waitcnt vmcnt(15)
    s_nop 0
    v_mfma_f32_16x16x32_bf16 v[20:23], v[16:19], v[96:99], v[20:23]
    v_and_b32_dpp v16, v5, v24 row_newbcast:5 row_mask:0xf bank_mask:1
    v_and_b32_dpp v17, v5, v24 row_newbcast:5 row_mask:0xf bank_mask:2
    v_and_b32_dpp v18, v5, v24 row_newbcast:5 row_mask:0xf bank_mask:4
    v_and_b32_dpp v19, v5, v24 row_newbcast:5 row_mask:0xf bank_mask:8
    s_waitcnt vmcnt(14)
    s_nop 0
    v_mfma_f32_16x16x32_bf16 v[20:23], v[16:19], v[100:103], v[20:23]
    v_and_b32_dpp v16, v5, v24 row_newbcast:6 row_mask:0xf bank_mask:1
    v_and_b32_dpp v17, v5, v24 row_newbcast:6 row_mask:0xf bank_mask:2
    v_and_b32_dpp v18, v5, v24 row_newbcast:6 row_mask:0xf bank_mask:4
    v_and_b32_dpp v19, v5, v24 row_newbcast:6 row_mask:0xf bank_mask:8
    s_waitcnt vmcnt(13)
    s_nop 0
    v_mfma_f32_16x16x32_bf16 v[20:23], v[16:19], v[104:107], v[20:23]
    v_and_b32_dpp v16, v5, v24 row_newbcast:7 row_mask:0xf bank_mask:1
    v_and_b32_dpp v17, v5, v24 row_newbcast:7 row_mask:0xf bank_mask:2
    v_and_b32_dpp v18, v5, v24 row_newbcast:7 row_mask:0xf bank_mask:4
    v_and_b32_dpp v19, v5, v24 row_newbcast:7 row_mask:0xf bank_mask:8
    s_waitcnt vmcnt(12)
    s_nop 0
    v_mfma_f32_16x16x32_bf16 v[20:23], v[16:19], v[108:111], v[20:23]
    v_and_b32_dpp v16, v5, v24 row_newbcast:8 row_mask:0xf bank_mask:1
    v_and_b32_dpp v17, v5, v24 row_newbcast:8 row_mask:0xf bank_mask:2
    v_and_b32_dpp v18, v5, v24 row_newbcast:8 row_mask:0xf bank_mask:4
    v_and_b32_dpp v19, v5, v24 row_newbcast:8 row_mask:0xf bank_mask:8
    s_waitcnt vmcnt(11)
    s_nop 0
    v_mfma_f32_16x16x32_bf16 v[20:23], v[16:19], v[112:115], v[20:23]
    v_and_b32_dpp v16, v5, v24 row_newbcast:9 row_mask:0xf bank_mask:1
    v_and_b32_dpp v17, v5, v24 row_newbcast:9 row_mask:0xf bank_mask:2
    v_and_b32_dpp v18, v5, v24 row_newbcast:9 row_mask:0xf bank_mask:4
    v_and_b32_dpp v19, v5, v24 row_newbcast:9 row_mask:0xf bank_mask:8
    s_waitcnt vmcnt(10)
    s_nop 0
    v_mfma_f32_16x16x32_bf16 v[20:23], v[16:19], v[116:119], v[20:23]
    v_and_b32_dpp v16, v5, v24 row_newbcast:10 row_mask:0xf bank_mask:1
    v_and_b32_dpp v17, v5, v24 row_newbcast:10 row_mask:0xf bank_mask:2
    v_and_b32_dpp v18, v5, v24 row_newbcast:10 row_mask:0xf bank_mask:4
    v_and_b32_dpp v19, v5, v24 row_newbcast:10 row_mask:0xf bank_mask:8
    s_waitcnt vmcnt(9)
    s_nop 0
    v_mfma_f32_16x16x32_bf16 v[20:23], v[16:19], v[120:123], v[20:23]
    v_and_b32_dpp v16, v5, v24 row_newbcast:11 row_mask:0xf bank_mask:1
    v_and_b32_dpp v17, v5, v24 row_newbcast:11 row_mask:0xf bank_mask:2
    v_and_b32_dpp v18, v5, v24 row_newbcast:11 row_mask:0xf bank_mask:4
    v_and_b32_dpp v19, v5, v24 row_newbcast:11 row_mask:0xf bank_mask:8
    s_waitcnt vmcnt(8)
    s_nop 0
    v_mfma_f32_16x16x32_bf16 v[20:23], v[16:19], v[124:127], v[20:23]
    v_and_b32_dpp v16, v5, v24 row_newbcast:12 row_mask:0xf bank_mask:1
    v_and_b32_dpp v17, v5, v24 row_newbcast:12 row_mask:0xf bank_mask:2
    v_and_b32_dpp v18, v5, v24 row_newbcast:12 row_mask:0xf bank_mask:4
    v_and_b32_dpp v19, v5, v24 row_newbcast:12 row_mask:0xf bank_mask:8
    s_waitcnt vmcnt(7)
    s_nop 0
    v_mfma_f32_16x16x32_bf16 v[20:23], v[16:19], v[128:131], v[20:23]
    v_and_b32_dpp v16, v5, v24 row_newbcast:13 row_mask:0xf bank_mask:1
    v_and_b32_dpp v17, v5, v24 row_newbcast:13 row_mask:0xf bank_mask:2
    v_and_b32_dpp v18, v5, v24 row_newbcast:13 row_mask:0xf bank_mask:4
    v_and_b32_dpp v19, v5, v24 row_newbcast:13 row_mask:0xf bank_mask:8
    s_waitcnt vmcnt(6)
    s_nop 0
    v_mfma_f32_16x16x32_bf16 v[20:23], v[16:19], v[132:135], v[20:23]
    v_and_b32_dpp v16, v5, v24 row_newbcast:14 row_mask:0xf bank_mask:1
    v_and_b32_dpp v17, v5, v24 row_newbcast:14 row_mask:0xf bank_mask:2
    v_and_b32_dpp v18, v5, v24 row_newbcast:14 row_mask:0xf bank_mask:4
    v_and_b32_dpp v19, v5, v24 row_newbcast:14 row_mask:0xf bank_mask:8
    s_waitcnt vmcnt(5)
    s_nop 0
    v_mfma_f32_16x16x32_bf16 v[20:23], v[16:19], v[136:139], v[20:23]
    v_and_b32_dpp v16, v5, v24 row_newbcast:15 row_mask:0xf bank_mask:1
    v_and_b32_dpp v17, v5, v24 row_newbcast:15 row_mask:0xf bank_mask:2
    v_and_b32_dpp v18, v5, v24 row_newbcast:15 row_mask:0xf bank_mask:4
    v_and_b32_dpp v19, v5, v24 row_newbcast:15 row_mask:0xf bank_mask:8
    s_waitcnt vmcnt(4)
    s_nop 0
    v_mfma_f32_16x16x32_bf16 v[20:23], v[16:19], v[140:143], v[20:23]
    v_and_b32_dpp v16, v6, v24 row_newbcast:0 row_mask:0xf bank_mask:1
    v_and_b32_dpp v17, v6, v24 row_newbcast:0 row_mask:0xf bank_mask:2
    v_and_b32_dpp v18, v6, v24 row_newbcast:0 row_mask:0xf bank_mask:4
    v_and_b32_dpp v19, v6, v24 row_newbcast:0 row_mask:0xf bank_mask:8
    s_waitcnt vmcnt(3)
    s_nop 0
    v_mfma_f32_16x16x32_bf16 v[20:23], v[16:19], v[144:147], v[20:23]
    v_and_b32_dpp v16, v6, v24 row_newbcast:1 row_mask:0xf bank_mask:1
    v_and_b32_dpp v17, v6, v24 row_newbcast:1 row_mask:0xf bank_mask:2
    v_and_b32_dpp v18, v6, v24 row_newbcast:1 row_mask:0xf bank_mask:4
    v_and_b32_dpp v19, v6, v24 row_newbcast:1 row_mask:0xf bank_mask:8
    s_waitcnt vmcnt(2)
    s_nop 0
    v_mfma_f32_16x16x32_bf16 v[20:23], v[16:19], v[148:151], v[20:23]
    v_and_b32_dpp v16, v6, v24 row_newbcast:2 row_mask:0xf bank_mask:1
    v_and_b32_dpp v17, v6, v24 row_newbcast:2 row_mask:0xf bank_mask:2
    v_and_b32_dpp v18, v6, v24 row_newbcast:2 row_mask:0xf bank_mask:4
    v_and_b32_dpp v19, v6, v24 row_newbcast:2 row_mask:0xf bank_mask:8
    s_waitcnt vmcnt(1)
    s_nop 0
    v_mfma_f32_16x16x32_bf16 v[20:23], v[16:19], v[152:155], v[20:23]
    v_and_b32_dpp v16, v6, v24 row_newbcast:3 row_mask:0xf bank_mask:1
    v_and_b32_dpp v17, v6, v24 row_newbcast:3 row_mask:0xf bank_mask:2
    v_and_b32_dpp v18, v6, v24 row_newbcast:3 row_mask:0xf bank_mask:4
    v_and_b32_dpp v19, v6, v24 row_newbcast:3 row_mask:0xf bank_mask:8
    s_waitcnt vmcnt(0)
    s_nop 0
    v_mfma_f32_16x16x32_bf16 v[20:23], v[16:19], v[156:159], v[20:23]
    s_mov_b64 s[48:49], exec
    s_mov_b64 s[50:51], exec
    s_mov_b64 s[52:53], exec
    s_mov_b64 s[54:55], exec
    s_mov_b64 s[56:57], exec
    s_mov_b64 s[58:59], exec
    s_mov_b64 s[60:61], exec
    s_mov_b64 s[62:63], exec
    s_mov_b64 s[64:65], exec
    v_bfi_b32 v2, v66, v64, v20
    v_bfi_b32 v3, v66, v65, v21
    buffer_store_dwordx2 v[2:3], v57, s[40:43], s44 offen sc1
    s_cmp_eq_u32 s3, 1
    s_cbranch_scc0 L_gath
    s_barrier
    s_cmp_lt_u32 s31, 5
    s_cbranch_scc0 L_bg
L_gath:
    s_sleep 12
    s_mov_b64 exec, s[48:49]
    buffer_load_dwordx2 v[32:33], v57, s[40:43], s45 offen offset:0 sc1
    s_mov_b64 exec, s[50:51]
    buffer_load_dwordx2 v[34:35], v57, s[40:43], s45 offen offset:1024 sc1
    s_mov_b64 exec, s[52:53]
    buffer_load_dwordx2 v[36:37], v57, s[40:43], s45 offen offset:2048 sc1
    s_mov_b64 exec, s[54:55]
    buffer_load_dwordx2 v[38:39], v57, s[40:43], s45 offen offset:3072 sc1
    s_mov_b64 exec, s[56:57]
    buffer_load_dwordx2 v[40:41], v57, s[40:43], s47 offen offset:0 sc1
    s_mov_b64 exec, s[58:59]
    buffer_load_dwordx2 v[42:43], v57, s[40:43], s47 offen offset:1024 sc1
    s_mov_b64 exec, s[60:61]
    buffer_load_dwordx2 v[44:45], v57, s[40:43], s47 offen offset:2048 sc1
    s_mov_b64 exec, s[62:63]
    buffer_load_dwordx2 v[46:47], v57, s[40:43], s47 offen offset:3072 sc1
    s_mov_b64 exec, s[64:65]
    s_mov_b64 vcc, 0
    s_waitcnt vmcnt(7)
    v_perm_b32 v2, v33, v32, v67
    v_xor_b32 v2, v2, v64
    v_and_b32 v3, 0xffffff00, v32
    v_and_b32 v4, 0xffffff00, v33
    v_or_b32_dpp v2, v2, v2 quad_perm:[1,0,3,2] row_mask:0xf bank_mask:0xf
    v_cmp_ne_u32 s[48:49], 0, v2
    s_or_b64 vcc, vcc, s[48:49]
    s_waitcnt vmcnt(6)
    v_perm_b32 v2, v35, v34, v67
    v_xor_b32 v2, v2, v64
    v_and_b32 v58, 0xffffff00, v34
    v_and_b32 v59, 0xffffff00, v35
    v_or_b32_dpp v2, v2, v2 quad_perm:[1,0,3,2] row_mask:0xf bank_mask:0xf
    v_cmp_ne_u32 s[50:51], 0, v2
    v_add_f32 v3, v3, v58
    v_add_f32 v4, v4, v59
    s_or_b64 vcc, vcc, s[50:51]
    s_waitcnt vmcnt(5)
    v_perm_b32 v2, v37, v36, v67
    v_xor_b32 v2, v2, v64
    v_and_b32 v58, 0xffffff00, v36
    v_and_b32 v59, 0xffffff00, v37
    v_or_b32_dpp v2, v2, v2 quad_perm:[1,0,3,2] row_mask:0xf bank_mask:0xf
    v_cmp_ne_u32 s[52:53], 0, v2
    v_add_f32 v3, v3, v58
    v_add_f32 v4, v4, v59
    s_or_b64 vcc, vcc, s[52:53]
    s_waitcnt vmcnt(4)
    v_perm_b32 v2, v39, v38, v67
    v_xor_b32 v2, v2, v64
    v_and_b32 v58, 0xffffff00, v38
    v_and_b32 v59, 0xffffff00, v39
    v_or_b32_dpp v2, v2, v2 quad_perm:[1,0,3,2] row_mask:0xf bank_mask:0xf
    v_cmp_ne_u32 s[54:55], 0, v2
    v_add_f32 v3, v3, v58
    v_add_f32 v4, v4, v59
    s_or_b64 vcc, vcc, s[54:55]
    s_waitcnt vmcnt(3)
    v_perm_b32 v2, v41, v40, v67
    v_xor_b32 v2, v2, v64
    v_and_b32 v58, 0xffffff00, v40
    v_and_b32 v59, 0xffffff00, v41
    v_or_b32_dpp v2, v2, v2 quad_perm:[1,0,3,2] row_mask:0xf bank_mask:0xf
    v_cmp_ne_u32 s[56:57], 0, v2
    v_add_f32 v3, v3, v58
    v_add_f32 v4, v4, v59
    s_or_b64 vcc, vcc, s[56:57]
    s_waitcnt vmcnt(2)
    v_perm_b32 v2, v43, v42, v67
    v_xor_b32 v2, v2, v64
    v_and_b32 v58, 0xffffff00, v42
    v_and_b32 v59, 0xffffff00, v43
    v_or_b32_dpp v2, v2, v2 quad_perm:[1,0,3,2] row_mask:0xf bank_mask:0xf
    v_cmp_ne_u32 s[58:59], 0, v2
    v_add_f32 v3, v3, v58
    v_add_f32 v4, v4, v59
    s_or_b64 vcc, vcc, s[58:59]
    s_waitcnt vmcnt(1)
    v_perm_b32 v2, v45, v44, v67
    v_xor_b32 v2, v2, v64
    v_and_b32 v58, 0xffffff00, v44
    v_and_b32 v59, 0xffffff00, v45
    v_or_b32_dpp v2, v2, v2 quad_perm:[1,0,3,2] row_mask:0xf bank_mask:0xf
    v_cmp_ne_u32 s[60:61], 0, v2
    v_add_f32 v3, v3, v58
    v_add_f32 v4, v4, v59
    s_or_b64 vcc, vcc, s[60:61]
    s_waitcnt vmcnt(0)
    v_perm_b32 v2, v47, v46, v67
    v_xor_b32 v2, v2, v64
    v_and_b32 v58, 0xffffff00, v46
    v_and_b32 v59, 0xffffff00, v47
    v_or_b32_dpp v2, v2, v2 quad_perm:[1,0,3,2] row_mask:0xf bank_mask:0xf
    v_cmp_ne_u32 s[62:63], 0, v2
    v_add_f32 v3, v3, v58
    v_add_f32 v4, v4, v59
    s_or_b64 vcc, vcc, s[62:63]
    s_cbranch_scc1 L_gath
    s_cmp_eq_u32 s3, 1
    s_cbranch_scc1 L_ffn
    v_cvt_pk_bf16_f32 v2, v3, v4
    ds_write_b32 v14, v2 offset:0
    s_mov_b64 exec, -1
L_b1:
    s_waitcnt lgkmcnt(0)
    s_barrier
L_b1p:
    s_waitcnt lgkmcnt(0)
    v_mov_b32 v20, 0
    v_mov_b32 v21, 0
    v_mov_b32 v22, 0
    v_mov_b32 v23, 0
L_bg:
    s_mov_b64 exec, -1
    s_add_u32 s32, s33, 0x9e3779b9
    v_mov_b32 v26, s32
    s_mov_b32 s56, s12
    s_mov_b32 s57, s13
    s_mov_b32 s59, 0x20000
    s_cmp_lt_u32 s31, 5
    s_cselect_b32 s58, 5242880, 0
    s_cselect_b32 s67, 2, 0
    s_lshl_b32 s34, s28, 2
    s_add_u32 s34, s34, s3
    s_mul_i32 s34, s34, 40960
    s_lshl_b32 s35, s31, 8
    s_add_u32 s69, s34, s35
    v_mul_u32_u24 v50, 1280, v8
    v_lshl_add_u32 v50, v9, 4, v50
    s_mov_b32 s60, s20
    s_mov_b32 s61, s21
    s_mov_b32 s63, 0x20000
    s_cmp_lt_u32 s28, 27
    s_cselect_b32 s62, s58, 0
    s_min_u32 s62, s62, 2211840
    s_lshl_b32 s54, s28, 2
    s_add_u32 s54, s54, s3
    s_mul_i32 s54, s54, 20480
    s_add_u32 s54, s54, s35
    s_add_u32 s55, s54, 10240
    v_mul_u32_u24 v51, 2560, v8
    v_lshl_add_u32 v51, v9, 4, v51
    s_lshl_b32 s34, s3, 1
    v_add_u32 v54, s34, v9
    v_and_b32 v54, 15, v54
    v_lshl_add_u32 v54, v8, 4, v54
    v_lshlrev_b32 v54, 3, v54
    s_cmp_lg_u32 s62, 0
    s_cselect_b32 s34, 8, 0
    s_or_b32 s67, s67, s34
L_nowo:
    s_lshl_b32 s44, s2, 9
    s_add_u32 s44, s44, 524288
    s_lshl_b32 s45, s28, 12
    s_lshl_b32 s35, s3, 7
    s_add_u32 s45, s45, s35
    s_add_u32 s45, s45, 524288
    s_mul_i32 s46, s28, 5
    s_add_u32 s46, s46, s31
    s_lshl_b32 s46, s46, 10
    s_add_u32 s46, s46, 786432
    v_cmp_gt_u32 vcc, 32, v1
    v_and_b32 v10, 7, v1
    v_lshrrev_b32 v11, 3, v1
    v_lshlrev_b32 v11, 9, v11
    v_lshl_add_u32 v10, v10, 4, v11
    v_cndmask_b32 v11, v27, v31, vcc
    v_and_b32 v12, 1, v1
    v_lshlrev_b32 v12, 2, v12
    v_and_b32 v28, 0x1f0, v31
    v_lshlrev_b32 v13, 6, v9
    v_lshl_add_u32 v13, v8, 4, v13
    s_lshl_b32 s35, s3, 9
    v_lshlrev_b32 v29, 3, v1
    v_add_u32 v14, s35, v29
    s_mul_i32 s34, s28, 3
    s_add_u32 s34, s34, s31
    s_sub_u32 s34, s34, 5
    s_cmp_lt_u32 s31, 5
    s_cselect_b32 s34, 80, s34
    s_cmp_eq_u32 s3, 1
    s_cselect_b32 s34, s34, 80
    s_cmp_lt_u32 s34, 80
    s_cselect_b32 s35, 4, 0
    s_or_b32 s67, s67, s35
    s_cmp_eq_u32 s3, 0
    s_cselect_b32 s35, 1, 0
    s_or_b32 s67, s67, s35
    s_lshl_b32 s47, s34, 6
    s_add_u32 s47, s47, 786432
    s_add_u32 s68, s47, 81920
    v_lshrrev_b32 v15, 2, v1
    v_mul_u32_u24 v15, 5120, v15
    v_and_b32 v2, 3, v1
    v_lshl_add_u32 v15, v2, 4, v15
    v_lshlrev_b32 v2, 2, v2
    v_lshrrev_b32 v3, 5, v1
    v_lshl_add_u32 v2, v3, 1, v2
    s_lshl_b32 s35, s34, 4
    v_add_u32 v2, s35, v2
    v_and_b32 v3, 28, v1
    v_cmp_eq_u32 vcc, 0, v3
    s_nop 1
    v_cndmask_b32 v7, v27, v2, vcc
    v_add_u32 v2, s34, v1
    v_cmp_eq_u32 vcc, 0, v2
    v_mov_b32 v6, 983040
    s_nop 0
    v_cndmask_b32 v6, v27, v6, vcc
    v_mov_b32 v45, v26
    v_mov_b32 v47, v26
    s_mov_b64 s[64:65], -1
    s_mov_b32 s66, s67
    s_cmp_eq_u32 s3, 2
    s_cbranch_scc1 L_ctl
    buffer_load_ushort v25, v7, s[36:39], 0 offen
    s_waitcnt vmcnt(0)
    v_lshlrev_b32 v25, 16, v25
    s_mov_b32 s36, s22
    s_mov_b32 s37, s23
    s_mov_b64 s[64:65], -1
    s_mov_b32 s66, s67
    s_cmp_eq_u32 s3, 2
    s_cbranch_scc1 L_ctl
    s_cmp_eq_u32 s3, 3
    s_cbranch_scc0 L_tail
    s_mov_b64 s[64:65], 0
    s_mov_b64 exec, 0
    s_mov_b32 s66, 15
    s_branch L_t0
L_tail:
    s_barrier
L_t0:
    ds_read_b64 v[52:53], v54 offset:3072
    buffer_load_dwordx4 v[96:99], v51, s[60:63], s54 offen offset:0 nt
    buffer_load_dwordx4 v[100:103], v51, s[60:63], s54 offen offset:1280 nt
    buffer_load_dwordx4 v[104:107], v51, s[60:63], s55 offen offset:0 nt
    buffer_load_dwordx4 v[108:111], v51, s[60:63], s55 offen offset:1280 nt
    s_mov_b32 s34, s69
    buffer_load_dwordx4 v[160:163], v50, s[56:59], s34 offen nt
    s_add_u32 s34, s34, 5120
    buffer_load_dwordx4 v[164:167], v50, s[56:59], s34 offen nt
    s_add_u32 s34, s34, 5120
    buffer_load_dwordx4 v[168:171], v50, s[56:59], s34 offen nt
    s_add_u32 s34, s34, 5120
    buffer_load_dwordx4 v[172:175], v50, s[56:59], s34 offen nt
    s_add_u32 s34, s34, 5120
    buffer_load_dwordx4 v[176:179], v50, s[56:59], s34 offen nt
    s_add_u32 s34, s34, 5120
    buffer_load_dwordx4 v[180:183], v50, s[56:59], s34 offen nt
    s_add_u32 s34, s34, 5120
    buffer_load_dwordx4 v[184:187], v50, s[56:59], s34 offen nt
    s_add_u32 s34, s34, 5120
    buffer_load_dwordx4 v[188:191], v50, s[56:59], s34 offen nt
    s_cbranch_execz L_t1
    s_barrier
L_t1:
    s_bitcmp1_b32 s66, 0
    s_cbranch_scc0 L_nopub
    ds_read_b128 v[32:35], v28 offset:512
    ds_read_b32 v38, v12 offset:288
    s_waitcnt lgkmcnt(1)
    v_cvt_pk_bf16_f32 v36, v32, v33
    v_cvt_pk_bf16_f32 v37, v34, v35
    v_bitop3_b32 v39, v36, v37, v26 bitop3:0x96
    s_waitcnt lgkmcnt(0)
    v_xor_b32 v39, v39, v38
    buffer_store_dwordx4 v[36:39], v11, s[40:43], s44 offen sc1
L_nopub:
    s_bitcmp1_b32 s66, 1
    s_cbranch_scc0 L_cons
    s_bitcmp1_b32 s66, 3
    s_cbranch_scc0 L_nwm
    s_waitcnt lgkmcnt(0)
    v_and_b32_dpp v16, v52, v24 row_newbcast:0 row_mask:0xf bank_mask:1
    v_and_b32_dpp v17, v52, v24 row_newbcast:0 row_mask:0xf bank_mask:2
    v_and_b32_dpp v18, v52, v24 row_newbcast:0 row_mask:0xf bank_mask:4
    v_and_b32_dpp v19, v52, v24 row_newbcast:0 row_mask:0xf bank_mask:8
    s_waitcnt vmcnt(11)
    s_nop 0
    v_mfma_f32_16x16x32_bf16 v[20:23], v[16:19], v[96:99], v[20:23]
    v_and_b32_dpp v16, v53, v24 row_newbcast:0 row_mask:0xf bank_mask:1
    v_and_b32_dpp v17, v53, v24 row_newbcast:0 row_mask:0xf bank_mask:2
    v_and_b32_dpp v18, v53, v24 row_newbcast:0 row_mask:0xf bank_mask:4
    v_and_b32_dpp v19, v53, v24 row_newbcast:0 row_mask:0xf bank_mask:8
    s_waitcnt vmcnt(10)
    s_nop 0
    v_mfma_f32_16x16x32_bf16 v[20:23], v[16:19], v[100:103], v[20:23]
    v_and_b32_dpp v16, v52, v24 row_newbcast:1 row_mask:0xf bank_mask:1
    v_and_b32_dpp v17, v52, v24 row_newbcast:1 row_mask:0xf bank_mask:2
    v_and_b32_dpp v18, v52, v24 row_newbcast:1 row_mask:0xf bank_mask:4
    v_and_b32_dpp v19, v52, v24 row_newbcast:1 row_mask:0xf bank_mask:8
    s_waitcnt vmcnt(9)
    s_nop 0
    v_mfma_f32_16x16x32_bf16 v[20:23], v[16:19], v[104:107], v[20:23]
    v_and_b32_dpp v16, v53, v24 row_newbcast:1 row_mask:0xf bank_mask:1
    v_and_b32_dpp v17, v53, v24 row_newbcast:1 row_mask:0xf bank_mask:2
    v_and_b32_dpp v18, v53, v24 row_newbcast:1 row_mask:0xf bank_mask:4
    v_and_b32_dpp v19, v53, v24 row_newbcast:1 row_mask:0xf bank_mask:8
    s_waitcnt vmcnt(8)
    s_nop 0
    v_mfma_f32_16x16x32_bf16 v[20:23], v[16:19], v[108:111], v[20:23]
L_nwm:
    s_mov_b64 s[48:49], exec
    buffer_load_dwordx4 v[80:83], v10, s[40:43], s45 offen sc1
    s_sleep 5
    buffer_load_dwordx4 v[84:87], v10, s[40:43], s45 offen sc1
    s_sleep 5
    buffer_load_dwordx4 v[88:91], v10, s[40:43], s45 offen sc1
    s_sleep 5
L_opoll:
    s_mov_b64 exec, s[48:49]
    buffer_load_dwordx4 v[92:95], v10, s[40:43], s45 offen sc1
    s_waitcnt vmcnt(3)
    v_bitop3_b32 v2, v80, v81, v82 bitop3:0x96
    v_xor_b32 v2, v2, v83
    v_cmp_eq_u32 vcc, v2, v26
    v_mov_b32 v32, v80
    v_mov_b32 v33, v81
    v_mov_b32 v34, v82
    s_andn2_b64 s[48:49], s[48:49], vcc
    s_cbranch_scc0 L_odone
    s_mov_b64 exec, s[48:49]
    buffer_load_dwordx4 v[80:83], v10, s[40:43], s45 offen sc1
    s_waitcnt vmcnt(3)
    v_bitop3_b32 v2, v84, v85, v86 bitop3:0x96
    v_xor_b32 v2, v2, v87
    v_cmp_eq_u32 vcc, v2, v26
    v_mov_b32 v32, v84
    v_mov_b32 v33, v85
    v_mov_b32 v34, v86
    s_andn2_b64 s[48:49], s[48:49], vcc
    s_cbranch_scc0 L_odone
    s_mov_b64 exec, s[48:49]
    buffer_load_dwordx4 v[84:87], v10, s[40:43], s45 offen sc1
    s_waitcnt vmcnt(3)
    v_bitop3_b32 v2, v88, v89, v90 bitop3:0x96
    v_xor_b32 v2, v2, v91
    v_cmp_eq_u32 vcc, v2, v26
    v_mov_b32 v32, v88
    v_mov_b32 v33, v89
    v_mov_b32 v34, v90
    s_andn2_b64 s[48:49], s[48:49], vcc
    s_cbranch_scc0 L_odone
    s_mov_b64 exec, s[48:49]
    buffer_load_dwordx4 v[88:91], v10, s[40:43], s45 offen sc1
    s_waitcnt vmcnt(3)
    v_bitop3_b32 v2, v92, v93, v94 bitop3:0x96
    v_xor_b32 v2, v2, v95
    v_cmp_eq_u32 vcc, v2, v26
    v_mov_b32 v32, v92
    v_mov_b32 v33, v93
    v_mov_b32 v34, v94
    s_andn2_b64 s[48:49], s[48:49], vcc
    s_cbranch_scc1 L_opoll
L_odone:
    s_mov_b64 exec, s[64:65]
    v_mov_b32_dpp v36, v34 quad_perm:[0,0,2,2] row_mask:0xf bank_mask:0xf
    v_mov_b32_dpp v37, v34 quad_perm:[1,1,3,3] row_mask:0xf bank_mask:0xf
    v_lshlrev_b32 v38, 16, v32
    v_max_f32_dpp v42, v36, v36 row_ror:8 row_mask:0xf bank_mask:0xf
    v_mov_b32 v43, v42
    v_and_b32 v39, 0xffff0000, v32
    v_lshlrev_b32 v40, 16, v33
    v_permlane16_swap_b32 v42, v43
    v_max_f32 v42, v42, v43
    v_mov_b32 v43, v42
    v_and_b32 v41, 0xffff0000, v33
    s_nop 0
    v_permlane32_swap_b32 v42, v43
    v_max_f32 v42, v42, v43
    v_sub_f32 v36, v36, v42
    v_exp_f32 v36, v36
    s_nop 0
    v_mul_f32 v37, v37, v36
    v_mul_f32 v38, v38, v36
    v_mul_f32 v40, v40, v36
    v_mov_b32 v43, v37
    v_mul_f32 v39, v39, v36
    v_mul_f32 v41, v41, v36
    v_permlane32_swap_b32 v37, v43
    v_permlane32_swap_b32 v38, v40
    v_permlane32_swap_b32 v39, v41
    v_add_f32 v36, v37, v43
    v_add_f32 v37, v37, v43
    v_add_f32 v38, v38, v40
    v_add_f32 v39, v39, v41
    v_permlane16_swap_b32 v36, v37
    s_nop 0
    v_permlane16_swap_b32 v38, v39
    v_add_f32 v36, v36, v37
    v_add_f32 v38, v38, v39
    s_nop 0
    v_add_f32_dpp v36, v36, v36 row_ror:8 row_mask:0xf bank_mask:0xf
    v_add_f32_dpp v38, v38, v38 row_ror:8 row_mask:0xf bank_mask:0xf
    v_rcp_f32 v36, v36
    s_nop 0
    v_mul_f32 v38, v38, v36
    v_cvt_pk_bf16_f32 v38, v38, v38
    s_nop 1
    v_and_b32_dpp v16, v38, v24 row_newbcast:0 row_mask:0xf bank_mask:1
    v_and_b32_dpp v17, v38, v24 row_newbcast:0 row_mask:0xf bank_mask:2
    v_and_b32_dpp v18, v38, v24 row_newbcast:0 row_mask:0xf bank_mask:4
    v_and_b32_dpp v19, v38, v24 row_newbcast:0 row_mask:0xf bank_mask:8
    s_nop 1
    v_mfma_f32_16x16x32_bf16 v[20:23], v[16:19], v[160:163], v[20:23]
    v_and_b32_dpp v16, v38, v24 row_newbcast:1 row_mask:0xf bank_mask:1
    v_and_b32_dpp v17, v38, v24 row_newbcast:1 row_mask:0xf bank_mask:2
    v_and_b32_dpp v18, v38, v24 row_newbcast:1 row_mask:0xf bank_mask:4
    v_and_b32_dpp v19, v38, v24 row_newbcast:1 row_mask:0xf bank_mask:8
    s_nop 1
    v_mfma_f32_16x16x32_bf16 v[20:23], v[16:19], v[164:167], v[20:23]
    v_and_b32_dpp v16, v38, v24 row_newbcast:2 row_mask:0xf bank_mask:1
    v_and_b32_dpp v17, v38, v24 row_newbcast:2 row_mask:0xf bank_mask:2
    v_and_b32_dpp v18, v38, v24 row_newbcast:2 row_mask:0xf bank_mask:4
    v_and_b32_dpp v19, v38, v24 row_newbcast:2 row_mask:0xf bank_mask:8
    s_nop 1
    v_mfma_f32_16x16x32_bf16 v[20:23], v[16:19], v[168:171], v[20:23]
    v_and_b32_dpp v16, v38, v24 row_newbcast:3 row_mask:0xf bank_mask:1
    v_and_b32_dpp v17, v38, v24 row_newbcast:3 row_mask:0xf bank_mask:2
    v_and_b32_dpp v18, v38, v24 row_newbcast:3 row_mask:0xf bank_mask:4
    v_and_b32_dpp v19, v38, v24 row_newbcast:3 row_mask:0xf bank_mask:8
    s_nop 1
    v_mfma_f32_16x16x32_bf16 v[20:23], v[16:19], v[172:175], v[20:23]
    v_and_b32_dpp v16, v38, v24 row_newbcast:4 row_mask:0xf bank_mask:1
    v_and_b32_dpp v17, v38, v24 row_newbcast:4 row_mask:0xf bank_mask:2
    v_and_b32_dpp v18, v38, v24 row_newbcast:4 row_mask:0xf bank_mask:4
    v_and_b32_dpp v19, v38, v24 row_newbcast:4 row_mask:0xf bank_mask:8
    s_nop 1
    v_mfma_f32_16x16x32_bf16 v[20:23], v[16:19], v[176:179], v[20:23]
    v_and_b32_dpp v16, v38, v24 row_newbcast:5 row_mask:0xf bank_mask:1
    v_and_b32_dpp v17, v38, v24 row_newbcast:5 row_mask:0xf bank_mask:2
    v_and_b32_dpp v18, v38, v24 row_newbcast:5 row_mask:0xf bank_mask:4
    v_and_b32_dpp v19, v38, v24 row_newbcast:5 row_mask:0xf bank_mask:8
    s_nop 1
    v_mfma_f32_16x16x32_bf16 v[20:23], v[16:19], v[180:183], v[20:23]
    v_and_b32_dpp v16, v38, v24 row_newbcast:6 row_mask:0xf bank_mask:1
    v_and_b32_dpp v17, v38, v24 row_newbcast:6 row_mask:0xf bank_mask:2
    v_and_b32_dpp v18, v38, v24 row_newbcast:6 row_mask:0xf bank_mask:4
    v_and_b32_dpp v19, v38, v24 row_newbcast:6 row_mask:0xf bank_mask:8
    s_nop 1
    v_mfma_f32_16x16x32_bf16 v[20:23], v[16:19], v[184:187], v[20:23]
    v_and_b32_dpp v16, v38, v24 row_newbcast:7 row_mask:0xf bank_mask:1
    v_and_b32_dpp v17, v38, v24 row_newbcast:7 row_mask:0xf bank_mask:2
    v_and_b32_dpp v18, v38, v24 row_newbcast:7 row_mask:0xf bank_mask:4
    v_and_b32_dpp v19, v38, v24 row_newbcast:7 row_mask:0xf bank_mask:8
    s_nop 1
    v_mfma_f32_16x16x32_bf16 v[20:23], v[16:19], v[188:191], v[20:23]
    s_nop 7
    ds_write_b64 v14, v[20:21] offset:1024
    s_waitcnt lgkmcnt(0)
    s_cbranch_execz L_t2
    s_barrier
L_t2:
    s_bitcmp1_b32 s66, 0
    s_cbranch_scc0 L_hend
    ds_read_b64 v[32:33], v29 offset:1536
    ds_read_b64 v[34:35], v29 offset:2048
    ds_read_b64 v[36:37], v29 offset:2560
    s_waitcnt lgkmcnt(1)
    v_add_f32 v20, v20, v32
    v_add_f32 v21, v21, v33
    v_add_f32 v20, v20, v34
    v_add_f32 v21, v21, v35
    s_waitcnt lgkmcnt(0)
    v_add_f32 v44, v20, v36
    v_add_f32 v46, v21, v37
    buffer_store_dwordx4 v[44:47], v13, s[40:43], s46 offen sc1
L_cons:
    s_bitcmp1_b32 s66, 2
    s_cbranch_scc0 L_hend
    s_mov_b64 s[48:49], exec
    s_mov_b64 s[50:51], exec
    s_mov_b64 exec, s[48:49]
    buffer_load_dwordx4 v[96:99], v15, s[40:43], s47 offen sc1
    s_mov_b64 exec, s[50:51]
    buffer_load_dwordx4 v[100:103], v15, s[40:43], s68 offen sc1
    s_sleep 10
L_ypoll:
    s_mov_b64 exec, s[48:49]
    buffer_load_dwordx4 v[104:107], v15, s[40:43], s47 offen sc1
    s_mov_b64 exec, s[50:51]
    buffer_load_dwordx4 v[108:111], v15, s[40:43], s68 offen sc1
    s_mov_b64 exec, s[48:49]
    s_waitcnt vmcnt(3)
    v_bitop3_b32 v2, v97, v99, v26 bitop3:0x7e
    v_mov_b32 v32, v96
    v_mov_b32 v34, v98
    v_cmp_ne_u32 s[48:49], 0, v2
    s_mov_b64 exec, s[50:51]
    s_waitcnt vmcnt(2)
    v_bitop3_b32 v2, v101, v103, v26 bitop3:0x7e
    v_mov_b32 v36, v100
    v_mov_b32 v38, v102
    v_cmp_ne_u32 s[50:51], 0, v2
    s_or_b64 vcc, s[48:49], s[50:51]
    s_cbranch_scc0 L_ydone
    s_mov_b64 exec, s[48:49]
    buffer_load_dwordx4 v[96:99], v15, s[40:43], s47 offen sc1
    s_mov_b64 exec, s[50:51]
    buffer_load_dwordx4 v[100:103], v15, s[40:43], s68 offen sc1
    s_mov_b64 exec, s[48:49]
    s_waitcnt vmcnt(3)
    v_bitop3_b32 v2, v105, v107, v26 bitop3:0x7e
    v_mov_b32 v32, v104
    v_mov_b32 v34, v106
    v_cmp_ne_u32 s[48:49], 0, v2
    s_mov_b64 exec, s[50:51]
    s_waitcnt vmcnt(2)
    v_bitop3_b32 v2, v109, v111, v26 bitop3:0x7e
    v_mov_b32 v36, v108
    v_mov_b32 v38, v110
    v_cmp_ne_u32 s[50:51], 0, v2
    s_or_b64 vcc, s[48:49], s[50:51]
    s_cbranch_scc1 L_ypoll
L_ydone:
    s_mov_b64 exec, s[64:65]
    v_add_f32 v2, v32, v36
    v_add_f32 v3, v34, v38
    s_nop 1
    v_permlane32_swap_b32 v2, v3
    v_add_f32 v4, v2, v3
    v_add_f32 v2, v2, v3
    s_nop 1
    v_permlane16_swap_b32 v2, v4
    v_add_f32 v2, v2, v4
    s_nop 1
    v_add_f32_dpp v2, v2, v2 row_ror:8 row_mask:0xf bank_mask:0xf
    s_nop 1
    v_add_f32_dpp v2, v2, v2 row_ror:4 row_mask:0xf bank_mask:0xf
    v_add_f32 v2, v2, v25
    v_cvt_pk_bf16_f32 v2, v2, v2
    buffer_store_short v2, v7, s[36:39], 0 offen
    buffer_store_dword v26, v6, s[40:43], 0 offen
L_hend:
    s_cbranch_execz L_dry2
    s_waitcnt vmcnt(0)
L_end:
    s_endpgm
L_dry2:
    s_mov_b64 s[64:65], -1
    s_mov_b64 exec, -1
    s_mov_b32 s66, s67
    s_nop 7
    s_nop 7
    v_mov_b32 v20, 0
    v_mov_b32 v21, 0
    v_mov_b32 v22, 0
    v_mov_b32 v23, 0
    s_branch L_tail
L_ctl:
    s_sub_u32 s34, s2, 64
    v_cmp_eq_u32 vcc, s34, v1
    s_nop 1
    v_cndmask_b32 v49, v27, v29, vcc
    s_mov_b32 s35, 0
    v_mov_b32 v35, -1
    v_mov_b32 v36, 300
    s_mov_b64 exec, 0xffff
L_cl:
    s_sleep 4
    ds_read_b64 v[44:45], v30 offset:296
    s_waitcnt lgkmcnt(0)
    v_readfirstlane_b32 s48, v45
    v_mov_b32 v45, v26
    s_cmp_le_u32 s48, s35
    s_cbranch_scc1 L_cl
    s_mul_i32 s34, s48, 128
    s_add_u32 s34, s34, 1048576
    s_sub_u32 s35, s34, 28160
    buffer_store_dwordx2 v[44:45], v49, s[40:43], s34 offen sc1
    buffer_load_dwordx2 v[32:33], v29, s[40:43], s35 offen sc1
    s_mov_b32 s35, s48
    s_waitcnt vmcnt(0)
    v_cmp_eq_u32 vcc, v33, v26
    v_sub_u32 v34, v32, v44
    s_nop 0
    v_cndmask_b32 v34, v36, v34, vcc
    s_cbranch_vccz L_cx
    s_nop 0
    v_add_u32_dpp v34, v34, v34 row_ror:8 row_mask:0xf bank_mask:0xf
    s_nop 1
    v_add_u32_dpp v34, v34, v34 row_ror:4 row_mask:0xf bank_mask:0xf
    s_nop 1
    v_add_u32_dpp v34, v34, v34 row_ror:2 row_mask:0xf bank_mask:0xf
    s_nop 1
    v_add_u32_dpp v34, v34, v34 row_ror:1 row_mask:0xf bank_mask:0xf
    v_ashrrev_i32 v34, 4, v34
    v_add_u32 v34, v34, v44
    ds_write_b64 v30, v[34:35] offset:304
L_cx:
    s_cmp_lt_u32 s48, 3080
    s_cbranch_scc1 L_cl
    s_mov_b64 exec, -1
    s_branch L_tail
L_nh0:
    s_waitcnt lgkmcnt(0)
    s_cmp_lt_u32 s28, 27
    s_cselect_b32 s35, 1, 0
    s_cmp_eq_u32 s3, s35
    s_cbranch_scc0 L_hset
    v_mul_u32_u24 v13, 3456, v12
    v_and_b32 v2, 7, v1
    v_lshl_add_u32 v13, v2, 4, v13
    s_lshl_b32 s44, s28, 7
    s_mov_b32 s58, 2211840
    s_mov_b32 s36, s4
    s_mov_b32 s37, s5
    s_mov_b32 s56, s16
    s_mov_b32 s57, s17
    buffer_load_dword v2, v7, s[36:39], 0 offen offset:0
    buffer_load_dword v3, v7, s[36:39], 0 offen offset:256
    buffer_load_dword v4, v7, s[36:39], 0 offen offset:512
    buffer_load_dword v5, v7, s[36:39], 0 offen offset:768
    buffer_load_dword v6, v7, s[36:39], 0 offen offset:1024
    s_mov_b32 exec_lo, 0x00ff00ff
    s_mov_b32 exec_hi, 0x00ff00ff
L_gu:
    buffer_load_dwordx4 v[80:83], v13, s[56:59], s44 offen nt
    s_add_u32 s44, s44, 13824
    buffer_load_dwordx4 v[84:87], v13, s[56:59], s44 offen nt
    s_add_u32 s44, s44, 13824
    buffer_load_dwordx4 v[88:91], v13, s[56:59], s44 offen nt
    s_add_u32 s44, s44, 13824
    buffer_load_dwordx4 v[92:95], v13, s[56:59], s44 offen nt
    s_add_u32 s44, s44, 13824
    buffer_load_dwordx4 v[96:99], v13, s[56:59], s44 offen nt
    s_add_u32 s44, s44, 13824
    buffer_load_dwordx4 v[100:103], v13, s[56:59], s44 offen nt
    s_add_u32 s44, s44, 13824
    buffer_load_dwordx4 v[104:107], v13, s[56:59], s44 offen nt
    s_add_u32 s44, s44, 13824
    buffer_load_dwordx4 v[108:111], v13, s[56:59], s44 offen nt
    s_add_u32 s44, s44, 13824
    buffer_load_dwordx4 v[112:115], v13, s[56:59], s44 offen nt
    s_add_u32 s44, s44, 13824
    buffer_load_dwordx4 v[116:119], v13, s[56:59], s44 offen nt
    s_add_u32 s44, s44, 13824
    buffer_load_dwordx4 v[120:123], v13, s[56:59], s44 offen nt
    s_add_u32 s44, s44, 13824
    buffer_load_dwordx4 v[124:127], v13, s[56:59], s44 offen nt
    s_add_u32 s44, s44, 13824
    buffer_load_dwordx4 v[128:131], v13, s[56:59], s44 offen nt
    s_add_u32 s44, s44, 13824
    buffer_load_dwordx4 v[132:135], v13, s[56:59], s44 offen nt
    s_add_u32 s44, s44, 13824
    buffer_load_dwordx4 v[136:139], v13, s[56:59], s44 offen nt
    s_add_u32 s44, s44, 13824
    buffer_load_dwordx4 v[140:143], v13, s[56:59], s44 offen nt
    s_add_u32 s44, s44, 13824
    buffer_load_dwordx4 v[144:147], v13, s[56:59], s44 offen nt
    s_add_u32 s44, s44, 13824
    buffer_load_dwordx4 v[148:151], v13, s[56:59], s44 offen nt
    s_add_u32 s44, s44, 13824
    buffer_load_dwordx4 v[152:155], v13, s[56:59], s44 offen nt
    s_add_u32 s44, s44, 13824
    buffer_load_dwordx4 v[156:159], v13, s[56:59], s44 offen nt
    s_mov_b32 s56, s18
    s_mov_b32 s57, s19
    s_lshl_b32 s44, s28, 7
    s_bitcmp1_b32 exec_lo, 0
    s_mov_b32 exec_lo, 0xff00ff00
    s_mov_b32 exec_hi, 0xff00ff00
    s_cbranch_scc1 L_gu
    s_mov_b64 exec, -1
    s_branch L_hset
L_h23:
    s_cmp_eq_u32 s3, 2
    s_cbranch_scc0 L_b1p
    v_lshlrev_b32 v2, 3, v1
    v_mov_b32 v3, -1.0
    ds_write_b64 v2, v[16:17] offset:512
    ds_write_b128 v30, v[16:19] offset:288
    ds_write_b64 v30, v[16:17] offset:304
    v_and_b32 v2, 24, v2
    ds_write_b32 v2, v3 offset:260
    s_mov_b64 exec, 0
    s_branch L_ln
L_ffn:
    s_mov_b64 exec, -1
    v_cvt_pk_bf16_f32 v3, 0, v3
    v_cvt_pk_bf16_f32 v4, 0, v4
    v_mul_f32 v52, 0xbfb8aa3b, v3
    v_exp_f32 v52, v52
    s_nop 0
    v_add_f32 v52, 1.0, v52
    v_rcp_f32 v52, v52
    s_nop 0
    v_mul_f32 v52, v3, v52
    v_cvt_pk_bf16_f32 v52, 0, v52
    s_nop 1
    v_mul_f32_dpp v52, v3, v52 row_ror:8 row_mask:0xf bank_mask:0xf
    v_cvt_pk_bf16_f32 v52, v52, v52
    v_mul_f32 v53, 0xbfb8aa3b, v4
    v_exp_f32 v53, v53
    s_nop 0
    v_add_f32 v53, 1.0, v53
    v_rcp_f32 v53, v53
    s_nop 0
    v_mul_f32 v53, v4, v53
    v_cvt_pk_bf16_f32 v53, 0, v53
    s_nop 1
    v_mul_f32_dpp v53, v4, v53 row_ror:8 row_mask:0xf bank_mask:0xf
    v_cvt_pk_bf16_f32 v53, v53, v53
    v_lshlrev_b32 v2, 3, v1
    ds_write_b64 v2, v[52:53] offset:3072
    v_mov_b32 v20, 0
    v_mov_b32 v21, 0
    v_mov_b32 v22, 0
    v_mov_b32 v23, 0
    s_waitcnt lgkmcnt(0)
    s_branch L_bg
.section .rodata,"a"
.p2align 6
.amdhsa_kernel parallel_sum__mha_block_cached__swiglu_ffn__decode_kernel
  .amdhsa_next_free_vgpr 240
  .amdhsa_next_free_sgpr 96
  .amdhsa_accum_offset 240
  .amdhsa_group_segment_fixed_size 0
  .amdhsa_kernarg_size 96
  .amdhsa_user_sgpr_count 2
  .amdhsa_user_sgpr_kernarg_segment_ptr 1
  .amdhsa_system_sgpr_workgroup_id_x 1
  .amdhsa_float_denorm_mode_32 3
.end_amdhsa_kernel
```
